```python
import torch

def _softmax(x, axis=-1):
    return torch.softmax(x, dim=axis)
def _gelu(x):
    return torch.nn.functional.gelu(x, approximate="tanh")
def _silu(x):
    return torch.nn.functional.silu(x)
def _sigmoid(x):
    return torch.sigmoid(x)
def _layernorm(x, axis=-1, eps=1e-5):
    m = x.mean(dim=axis, keepdim=True)
    v = x.var(dim=axis, keepdim=True, unbiased=False)
    return (x - m) / torch.sqrt(v + eps)
def _scatter_add(tgt, idx, src, axis=0):
    return tgt.clone().index_add_(axis, idx, src)
def _segment_sum(src, seg, n):
    out = torch.zeros((n,) + src.shape[1:], dtype=src.dtype)
    return out.index_add_(0, seg, src)
def _pad(x, pw):
    flat = tuple(v for pair in reversed(pw) for v in pair)
    return torch.nn.functional.pad(x, flat)

kernel_name = 'standalone__kv_cache_quant_int4_int2_kv_with_per_channel_or_per_token_scales__prompt'

def setup_inputs():

    _w = (lambda a: (lambda t: t.to(torch.bfloat16) if t.is_floating_point() else t)(torch.as_tensor(a)))
    B = 1
    Sq = 2048
    Skv = 2048
    Hq = 32
    Hkv = 8
    Dh = 128
    bits = 8
    G = 64
    if G <= 0 or G >= Skv:
        G = max(1, Skv // 2)
    Skv = (Skv // G) * G
    ngk = Skv // G
    qmax = (1 << bits) - 1
    return {
        "q": _w((lambda *s: torch.randn(*s, dtype=torch.bfloat16) * 0.2)(B, Hq, Sq, Dh)),
        "qk": _w(torch.randint(0, qmax + 1, (B, Hkv, Skv, Dh)).to(torch.int32)),
        "qv": _w(torch.randint(0, qmax + 1, (B, Hkv, Skv, Dh)).to(torch.int32)),
        "k_scales": _w(torch.abs((lambda *s: torch.randn(*s, dtype=torch.bfloat16) * 0.2)(B, Hkv, ngk, Dh)) * 0.05 + 0.02),
        "k_zeros": _w((lambda *s: torch.randn(*s, dtype=torch.bfloat16) * 0.2)(B, Hkv, ngk, Dh) + float(qmax) / 2.0),
        "v_scales": _w(torch.abs((lambda *s: torch.randn(*s, dtype=torch.bfloat16) * 0.05)(B, Hkv, Skv, 1)) * 0.05 + 0.02),
        "v_zeros": _w((lambda *s: torch.randn(*s, dtype=torch.bfloat16) * 0.05)(B, Hkv, Skv, 1) + float(qmax) / 2.0),
    }

def reference(q, qk, qv, k_scales, k_zeros, v_scales, v_zeros):
    B, Hq, Sq, Dh = q.shape
    Hkv, Skv = qk.shape[1], qk.shape[2]
    ngk = k_scales.shape[2]
    G = Skv // ngk
    ks = (lambda x, n, axis: torch.repeat_interleave(x, n, dim=axis))(k_scales, G, axis=2)
    kz = (lambda x, n, axis: torch.repeat_interleave(x, n, dim=axis))(k_zeros, G, axis=2)
    k = ((lambda x, dt: x.to(dt))(qk, q.dtype) - kz) * ks
    v = ((lambda x, dt: x.to(dt))(qv, q.dtype) - v_zeros) * v_scales
    rep = Hq // Hkv
    if rep > 1:
        k = (lambda x, n, axis: torch.repeat_interleave(x, n, dim=axis))(k, rep, axis=1)
        v = (lambda x, n, axis: torch.repeat_interleave(x, n, dim=axis))(v, rep, axis=1)
    scale = float(Dh) ** -0.5
    logits = torch.einsum("bhqd,bhkd->bhqk", q, k) * scale
    p = _softmax(logits, axis=-1)
    o = torch.einsum("bhqk,bhkd->bhqd", p, v)
    return o
```

```asm
; @launch grid=(256,1,1) block=(256,1,1) lds=147712
.amdgcn_target "amdgcn-amd-amdhsa--gfx950"
.text
.globl standalone__kv_cache_quant_int4_int2_kv_with_per_channel_or_per_token_scales__prompt_kernel
.p2align 8
.type standalone__kv_cache_quant_int4_int2_kv_with_per_channel_or_per_token_scales__prompt_kernel,@function
standalone__kv_cache_quant_int4_int2_kv_with_per_channel_or_per_token_scales__prompt_kernel:
    s_cmp_ge_u32 s2, 256
    s_cbranch_scc1 L_done
    s_load_dwordx16 s[24:39], s[0:1], 0
    s_load_dwordx4 s[40:43], s[0:1], 64
    v_lshrrev_b32 v3, 6, v0
    v_and_b32 v0, 63, v0
    v_readfirstlane_b32 s16, v3
    v_lshlrev_b32 v1, 4, v0
    v_add_u32 v2, 0x10000, v1
    v_add_u32 v3, 131072, v1
    v_and_b32 v4, 15, v0
    v_lshrrev_b32 v5, 4, v0
    v_lshlrev_b32 v6, 9, v4
    v_lshl_add_u32 v6, v5, 5, v6
    v_and_b32 v7, 2, v4
    v_lshlrev_b32 v7, 2, v7
    v_lshrrev_b32 v8, 2, v4
    v_lshl_add_u32 v7, v8, 1, v7
    v_and_b32 v8, 1, v4
    v_add_u32 v7, v7, v8
    v_lshlrev_b32 v7, 4, v7
    v_lshl_add_u32 v7, v5, 11, v7
    v_lshlrev_b32 v8, 4, v5
    v_lshlrev_b32 v9, 3, v5
    v_lshlrev_b32 v10, 8, v4
    v_lshl_add_u32 v10, v5, 4, v10
    v_mov_b32 v14, 147456
    s_and_b32 s72, s2, 7
    s_lshr_b32 s73, s2, 3
    s_and_b32 s75, s73, 3
    s_lshl_b32 s88, s72, 2
    s_add_u32 s88, s88, s75
    s_lshr_b32 s75, s73, 2
    s_lshl_b32 s88, s88, 19
    s_lshl_b32 s75, s75, 16
    s_add_u32 s88, s88, s75
    s_lshl_b32 s75, s16, 14
    s_add_u32 s88, s88, s75
    s_add_u32 s89, s88, 4096
    s_add_u32 s90, s88, 8192
    s_add_u32 s91, s88, 12288
    s_mov_b32 s18, 0x47800000
    s_lshl_b32 s20, s16, 13
    s_lshl_b32 s23, s72, 19
    s_and_b32 s75, s16, 1
    s_lshr_b32 s76, s16, 1
    s_lshl_b32 s77, s75, 1
    s_add_u32 s76, s76, s77
    s_lshl_b32 s77, s73, 1
    s_add_u32 s76, s76, s77
    s_lshl_b32 s22, s76, 13
    s_and_b32 s22, s22, 0x7ffff
    s_cmp_eq_u32 s75, 1
    s_cselect_b32 s76, 0, 4194304
    s_add_u32 s23, s23, s76
    s_add_u32 s74, s73, 1
    s_and_b32 s74, s74, 31
    s_add_u32 s83, s73, 2
    s_and_b32 s83, s83, 31
    s_lshl_b32 s75, s16, 10
    v_add_u32 v11, s75, v1
    v_add_u32 v13, s75, v3
    s_lshr_b32 s75, s16, 1
    s_lshl_b32 s75, s75, 14
    s_and_b32 s76, s16, 1
    s_lshl_b32 s76, s76, 12
    s_add_u32 s75, s75, s76
    v_add_u32 v15, s75, v1
    s_lshl_b32 s76, s72, 5
    v_mov_b32 v12, s76
    s_waitcnt lgkmcnt(0)
    s_mov_b32 s4, s24
    s_mov_b32 s5, s25
    s_mov_b32 s6, 16777216
    s_mov_b32 s7, 0x00020000
    s_mov_b32 s8, s42
    s_mov_b32 s9, s43
    s_mov_b32 s10, 8388608
    s_mov_b32 s11, 0x00020000
    s_mov_b32 s12, s38
    s_mov_b32 s13, s39
    s_mov_b32 s14, 16777216
    s_mov_b32 s15, 0x00020000
    s_mov_b32 s44, s26
    s_mov_b32 s45, s27
    s_mov_b32 s46, 8388608
    s_mov_b32 s47, 0x00020000
    s_mov_b32 s48, s28
    s_mov_b32 s49, s29
    s_mov_b32 s50, 8388608
    s_mov_b32 s51, 0x00020000
    s_mov_b32 s52, s30
    s_mov_b32 s53, s31
    s_mov_b32 s54, 65536
    s_mov_b32 s55, 0x00020000
    s_mov_b32 s56, s32
    s_mov_b32 s57, s33
    s_mov_b32 s58, 65536
    s_mov_b32 s59, 0x00020000
    s_mov_b32 s60, s34
    s_mov_b32 s61, s35
    s_mov_b32 s62, 32768
    s_mov_b32 s63, 0x00020000
    s_mov_b32 s64, s36
    s_mov_b32 s65, s37
    s_mov_b32 s66, 32768
    s_mov_b32 s67, 0x00020000
    s_mov_b32 s68, s40
    s_mov_b32 s69, s41
    s_mov_b32 s70, 256
    s_mov_b32 s71, 0x00020000
    s_lshl_b32 s75, s72, 11
    s_lshl_b32 s76, s73, 6
    s_add_u32 s75, s75, s76
    s_lshl_b32 s76, s72, 5
    s_add_u32 s76, s76, s73
    s_lshl_b32 s76, s76, 8
    s_lshl_b32 s77, s16, 6
    s_add_u32 s76, s76, s77
    s_lshr_b32 s77, s16, 1
    s_lshl_b32 s77, s77, 5
    s_add_u32 s77, s77, s75
    s_lshl_b32 s79, s77, 9
    s_lshl_b32 s77, s77, 1
    s_and_b32 s78, s16, 1
    s_lshl_b32 s78, s78, 8
    s_add_u32 s79, s79, s78
    s_lshl_b32 s78, s75, 9
    s_lshl_b32 s80, s16, 7
    s_add_u32 s78, s78, s80
    buffer_load_dwordx4 v[176:179], v8, s[52:55], s76 offen
    buffer_load_dwordx4 v[180:183], v8, s[56:59], s76 offen
    buffer_load_dwordx4 v[16:19], v6, s[44:47], s78 offen offset:0 nt
    buffer_load_dwordx4 v[20:23], v6, s[44:47], s78 offen offset:16 nt
    s_add_u32 s78, s78, 8192
    buffer_load_dwordx4 v[24:27], v6, s[44:47], s78 offen offset:0 nt
    buffer_load_dwordx4 v[28:31], v6, s[44:47], s78 offen offset:16 nt
    s_add_u32 s78, s78, 8192
    buffer_load_dwordx4 v[32:35], v6, s[44:47], s78 offen offset:0 nt
    buffer_load_dwordx4 v[36:39], v6, s[44:47], s78 offen offset:16 nt
    s_add_u32 s78, s78, 8192
    buffer_load_dwordx4 v[40:43], v6, s[44:47], s78 offen offset:0 nt
    buffer_load_dwordx4 v[44:47], v6, s[44:47], s78 offen offset:16 nt
    buffer_load_dwordx2 v[184:185], v9, s[60:63], s77 offen offset:0
    buffer_load_dwordx2 v[186:187], v9, s[60:63], s77 offen offset:32
    buffer_load_dwordx2 v[188:189], v9, s[64:67], s77 offen offset:0
    buffer_load_dwordx2 v[190:191], v9, s[64:67], s77 offen offset:32
    buffer_load_dwordx4 v[48:51], v7, s[48:51], s79 offen offset:0 nt
    buffer_load_dwordx4 v[52:55], v7, s[48:51], s79 offen offset:512 nt
    buffer_load_dwordx4 v[56:59], v7, s[48:51], s79 offen offset:1024 nt
    buffer_load_dwordx4 v[60:63], v7, s[48:51], s79 offen offset:1536 nt
    s_add_u32 s79, s79, 8192
    buffer_load_dwordx4 v[64:67], v7, s[48:51], s79 offen offset:0 nt
    buffer_load_dwordx4 v[68:71], v7, s[48:51], s79 offen offset:512 nt
    buffer_load_dwordx4 v[72:75], v7, s[48:51], s79 offen offset:1024 nt
    buffer_load_dwordx4 v[76:79], v7, s[48:51], s79 offen offset:1536 nt
    s_lshl_b32 s81, s72, 19
    s_lshl_b32 s80, s73, 14
    s_add_u32 s81, s81, s80
    s_lshl_b32 s80, s16, 12
    s_add_u32 s82, s81, s80
    s_add_u32 s82, s82, 4194304
    s_lshl_b32 s80, s16, 10
    s_add_u32 s81, s81, s80
    v_mov_b32 v240, 0x3e0293ee
    v_mov_b32 v241, 0x3e0293ee
    v_accvgpr_write_b32 a0, 0
    v_accvgpr_write_b32 a1, 0
    v_accvgpr_write_b32 a2, 0
    v_accvgpr_write_b32 a3, 0
    v_accvgpr_write_b32 a4, 0
    v_accvgpr_write_b32 a5, 0
    v_accvgpr_write_b32 a6, 0
    v_accvgpr_write_b32 a7, 0
    v_accvgpr_write_b32 a8, 0
    v_accvgpr_write_b32 a9, 0
    v_accvgpr_write_b32 a10, 0
    v_accvgpr_write_b32 a11, 0
    v_accvgpr_write_b32 a12, 0
    v_accvgpr_write_b32 a13, 0
    v_accvgpr_write_b32 a14, 0
    v_accvgpr_write_b32 a15, 0
    v_accvgpr_write_b32 a16, 0
    v_accvgpr_write_b32 a17, 0
    v_accvgpr_write_b32 a18, 0
    v_accvgpr_write_b32 a19, 0
    v_accvgpr_write_b32 a20, 0
    v_accvgpr_write_b32 a21, 0
    v_accvgpr_write_b32 a22, 0
    v_accvgpr_write_b32 a23, 0
    v_accvgpr_write_b32 a24, 0
    v_accvgpr_write_b32 a25, 0
    v_accvgpr_write_b32 a26, 0
    v_accvgpr_write_b32 a27, 0
    v_accvgpr_write_b32 a28, 0
    v_accvgpr_write_b32 a29, 0
    v_accvgpr_write_b32 a30, 0
    v_accvgpr_write_b32 a31, 0
    v_accvgpr_write_b32 a32, 0
    v_accvgpr_write_b32 a33, 0
    v_accvgpr_write_b32 a34, 0
    v_accvgpr_write_b32 a35, 0
    v_accvgpr_write_b32 a36, 0
    v_accvgpr_write_b32 a37, 0
    v_accvgpr_write_b32 a38, 0
    v_accvgpr_write_b32 a39, 0
    v_accvgpr_write_b32 a40, 0
    v_accvgpr_write_b32 a41, 0
    v_accvgpr_write_b32 a42, 0
    v_accvgpr_write_b32 a43, 0
    v_accvgpr_write_b32 a44, 0
    v_accvgpr_write_b32 a45, 0
    v_accvgpr_write_b32 a46, 0
    v_accvgpr_write_b32 a47, 0
    v_accvgpr_write_b32 a48, 0
    v_accvgpr_write_b32 a49, 0
    v_accvgpr_write_b32 a50, 0
    v_accvgpr_write_b32 a51, 0
    v_accvgpr_write_b32 a52, 0
    v_accvgpr_write_b32 a53, 0
    v_accvgpr_write_b32 a54, 0
    v_accvgpr_write_b32 a55, 0
    v_accvgpr_write_b32 a56, 0
    v_accvgpr_write_b32 a57, 0
    v_accvgpr_write_b32 a58, 0
    v_accvgpr_write_b32 a59, 0
    v_accvgpr_write_b32 a60, 0
    v_accvgpr_write_b32 a61, 0
    v_accvgpr_write_b32 a62, 0
    v_accvgpr_write_b32 a63, 0
    v_accvgpr_write_b32 a64, 0
    v_accvgpr_write_b32 a65, 0
    v_accvgpr_write_b32 a66, 0
    v_accvgpr_write_b32 a67, 0
    v_accvgpr_write_b32 a68, 0
    v_accvgpr_write_b32 a69, 0
    v_accvgpr_write_b32 a70, 0
    v_accvgpr_write_b32 a71, 0
    v_accvgpr_write_b32 a72, 0
    v_accvgpr_write_b32 a73, 0
    v_accvgpr_write_b32 a74, 0
    v_accvgpr_write_b32 a75, 0
    v_accvgpr_write_b32 a76, 0
    v_accvgpr_write_b32 a77, 0
    v_accvgpr_write_b32 a78, 0
    v_accvgpr_write_b32 a79, 0
    v_accvgpr_write_b32 a80, 0
    v_accvgpr_write_b32 a81, 0
    v_accvgpr_write_b32 a82, 0
    v_accvgpr_write_b32 a83, 0
    v_accvgpr_write_b32 a84, 0
    v_accvgpr_write_b32 a85, 0
    v_accvgpr_write_b32 a86, 0
    v_accvgpr_write_b32 a87, 0
    v_accvgpr_write_b32 a88, 0
    v_accvgpr_write_b32 a89, 0
    v_accvgpr_write_b32 a90, 0
    v_accvgpr_write_b32 a91, 0
    v_accvgpr_write_b32 a92, 0
    v_accvgpr_write_b32 a93, 0
    v_accvgpr_write_b32 a94, 0
    v_accvgpr_write_b32 a95, 0
    v_accvgpr_write_b32 a96, 0
    v_accvgpr_write_b32 a97, 0
    v_accvgpr_write_b32 a98, 0
    v_accvgpr_write_b32 a99, 0
    v_accvgpr_write_b32 a100, 0
    v_accvgpr_write_b32 a101, 0
    v_accvgpr_write_b32 a102, 0
    v_accvgpr_write_b32 a103, 0
    v_accvgpr_write_b32 a104, 0
    v_accvgpr_write_b32 a105, 0
    v_accvgpr_write_b32 a106, 0
    v_accvgpr_write_b32 a107, 0
    v_accvgpr_write_b32 a108, 0
    v_accvgpr_write_b32 a109, 0
    v_accvgpr_write_b32 a110, 0
    v_accvgpr_write_b32 a111, 0
    v_accvgpr_write_b32 a112, 0
    v_accvgpr_write_b32 a113, 0
    v_accvgpr_write_b32 a114, 0
    v_accvgpr_write_b32 a115, 0
    v_accvgpr_write_b32 a116, 0
    v_accvgpr_write_b32 a117, 0
    v_accvgpr_write_b32 a118, 0
    v_accvgpr_write_b32 a119, 0
    v_accvgpr_write_b32 a120, 0
    v_accvgpr_write_b32 a121, 0
    v_accvgpr_write_b32 a122, 0
    v_accvgpr_write_b32 a123, 0
    v_accvgpr_write_b32 a124, 0
    v_accvgpr_write_b32 a125, 0
    v_accvgpr_write_b32 a126, 0
    v_accvgpr_write_b32 a127, 0
    s_waitcnt vmcnt(20)
    v_lshlrev_b32 v216, 16, v176
    v_and_b32 v217, 0xffff0000, v176
    v_lshlrev_b32 v218, 16, v177
    v_and_b32 v219, 0xffff0000, v177
    v_lshlrev_b32 v220, 16, v178
    v_and_b32 v221, 0xffff0000, v178
    v_lshlrev_b32 v222, 16, v179
    v_and_b32 v223, 0xffff0000, v179
    v_lshlrev_b32 v224, 16, v180
    v_and_b32 v225, 0xffff0000, v180
    v_lshlrev_b32 v226, 16, v181
    v_and_b32 v227, 0xffff0000, v181
    v_lshlrev_b32 v228, 16, v182
    v_and_b32 v229, 0xffff0000, v182
    v_lshlrev_b32 v230, 16, v183
    v_and_b32 v231, 0xffff0000, v183
    s_waitcnt vmcnt(18)
    v_cvt_f32_i32 v16, v16
    v_cvt_f32_i32 v17, v17
    v_cvt_f32_i32 v18, v18
    v_cvt_f32_i32 v19, v19
    v_cvt_f32_i32 v20, v20
    v_cvt_f32_i32 v21, v21
    v_cvt_f32_i32 v22, v22
    v_cvt_f32_i32 v23, v23
    v_cvt_pk_bf16_f32 v232, v16, v17
    v_cvt_pk_bf16_f32 v233, v18, v19
    v_cvt_pk_bf16_f32 v234, v20, v21
    v_cvt_pk_bf16_f32 v235, v22, v23
    v_lshlrev_b32 v16, 16, v232
    v_and_b32 v17, 0xffff0000, v232
    v_lshlrev_b32 v18, 16, v233
    v_and_b32 v19, 0xffff0000, v233
    v_lshlrev_b32 v20, 16, v234
    v_and_b32 v21, 0xffff0000, v234
    v_lshlrev_b32 v22, 16, v235
    v_and_b32 v23, 0xffff0000, v235
    v_pk_add_f32 v[16:17], v[16:17], v[224:225] neg_lo:[0,1] neg_hi:[0,1]
    v_pk_add_f32 v[18:19], v[18:19], v[226:227] neg_lo:[0,1] neg_hi:[0,1]
    v_pk_add_f32 v[20:21], v[20:21], v[228:229] neg_lo:[0,1] neg_hi:[0,1]
    v_pk_add_f32 v[22:23], v[22:23], v[230:231] neg_lo:[0,1] neg_hi:[0,1]
    v_cvt_pk_bf16_f32 v232, v16, v17
    v_cvt_pk_bf16_f32 v233, v18, v19
    v_cvt_pk_bf16_f32 v234, v20, v21
    v_cvt_pk_bf16_f32 v235, v22, v23
    v_lshlrev_b32 v16, 16, v232
    v_and_b32 v17, 0xffff0000, v232
    v_lshlrev_b32 v18, 16, v233
    v_and_b32 v19, 0xffff0000, v233
    v_lshlrev_b32 v20, 16, v234
    v_and_b32 v21, 0xffff0000, v234
    v_lshlrev_b32 v22, 16, v235
    v_and_b32 v23, 0xffff0000, v235
    v_pk_mul_f32 v[16:17], v[16:17], v[216:217]
    v_pk_mul_f32 v[18:19], v[18:19], v[218:219]
    v_pk_mul_f32 v[20:21], v[20:21], v[220:221]
    v_pk_mul_f32 v[22:23], v[22:23], v[222:223]
    v_cvt_pk_bf16_f32 v232, v16, v17
    v_cvt_pk_bf16_f32 v233, v18, v19
    v_cvt_pk_bf16_f32 v234, v20, v21
    v_cvt_pk_bf16_f32 v235, v22, v23
    v_lshlrev_b32 v16, 16, v232
    v_and_b32 v17, 0xffff0000, v232
    v_lshlrev_b32 v18, 16, v233
    v_and_b32 v19, 0xffff0000, v233
    v_lshlrev_b32 v20, 16, v234
    v_and_b32 v21, 0xffff0000, v234
    v_lshlrev_b32 v22, 16, v235
    v_and_b32 v23, 0xffff0000, v235
    v_pk_mul_f32 v[16:17], v[16:17], v[240:241]
    v_pk_mul_f32 v[18:19], v[18:19], v[240:241]
    v_pk_mul_f32 v[20:21], v[20:21], v[240:241]
    v_pk_mul_f32 v[22:23], v[22:23], v[240:241]
    v_cvt_pk_bf16_f32 v244, v16, v17
    v_cvt_pk_bf16_f32 v245, v18, v19
    v_cvt_pk_bf16_f32 v246, v20, v21
    v_cvt_pk_bf16_f32 v247, v22, v23
    buffer_store_dwordx4 v[244:247], v1, s[8:11], s81 offen sc1
    s_add_u32 s81, s81, 4096
    ds_write_b128 v13, v[244:247] offset:0
    s_waitcnt vmcnt(17)
    v_cvt_f32_i32 v24, v24
    v_cvt_f32_i32 v25, v25
    v_cvt_f32_i32 v26, v26
    v_cvt_f32_i32 v27, v27
    v_cvt_f32_i32 v28, v28
    v_cvt_f32_i32 v29, v29
    v_cvt_f32_i32 v30, v30
    v_cvt_f32_i32 v31, v31
    v_cvt_pk_bf16_f32 v232, v24, v25
    v_cvt_pk_bf16_f32 v233, v26, v27
    v_cvt_pk_bf16_f32 v234, v28, v29
    v_cvt_pk_bf16_f32 v235, v30, v31
    v_lshlrev_b32 v24, 16, v232
    v_and_b32 v25, 0xffff0000, v232
    v_lshlrev_b32 v26, 16, v233
    v_and_b32 v27, 0xffff0000, v233
    v_lshlrev_b32 v28, 16, v234
    v_and_b32 v29, 0xffff0000, v234
    v_lshlrev_b32 v30, 16, v235
    v_and_b32 v31, 0xffff0000, v235
    v_pk_add_f32 v[24:25], v[24:25], v[224:225] neg_lo:[0,1] neg_hi:[0,1]
    v_pk_add_f32 v[26:27], v[26:27], v[226:227] neg_lo:[0,1] neg_hi:[0,1]
    v_pk_add_f32 v[28:29], v[28:29], v[228:229] neg_lo:[0,1] neg_hi:[0,1]
    v_pk_add_f32 v[30:31], v[30:31], v[230:231] neg_lo:[0,1] neg_hi:[0,1]
    v_cvt_pk_bf16_f32 v232, v24, v25
    v_cvt_pk_bf16_f32 v233, v26, v27
    v_cvt_pk_bf16_f32 v234, v28, v29
    v_cvt_pk_bf16_f32 v235, v30, v31
    v_lshlrev_b32 v24, 16, v232
    v_and_b32 v25, 0xffff0000, v232
    v_lshlrev_b32 v26, 16, v233
    v_and_b32 v27, 0xffff0000, v233
    v_lshlrev_b32 v28, 16, v234
    v_and_b32 v29, 0xffff0000, v234
    v_lshlrev_b32 v30, 16, v235
    v_and_b32 v31, 0xffff0000, v235
    v_pk_mul_f32 v[24:25], v[24:25], v[216:217]
    v_pk_mul_f32 v[26:27], v[26:27], v[218:219]
    v_pk_mul_f32 v[28:29], v[28:29], v[220:221]
    v_pk_mul_f32 v[30:31], v[30:31], v[222:223]
    v_cvt_pk_bf16_f32 v232, v24, v25
    v_cvt_pk_bf16_f32 v233, v26, v27
    v_cvt_pk_bf16_f32 v234, v28, v29
    v_cvt_pk_bf16_f32 v235, v30, v31
    v_lshlrev_b32 v24, 16, v232
    v_and_b32 v25, 0xffff0000, v232
    v_lshlrev_b32 v26, 16, v233
    v_and_b32 v27, 0xffff0000, v233
    v_lshlrev_b32 v28, 16, v234
    v_and_b32 v29, 0xffff0000, v234
    v_lshlrev_b32 v30, 16, v235
    v_and_b32 v31, 0xffff0000, v235
    v_pk_mul_f32 v[24:25], v[24:25], v[240:241]
    v_pk_mul_f32 v[26:27], v[26:27], v[240:241]
    v_pk_mul_f32 v[28:29], v[28:29], v[240:241]
    v_pk_mul_f32 v[30:31], v[30:31], v[240:241]
    v_cvt_pk_bf16_f32 v248, v24, v25
    v_cvt_pk_bf16_f32 v249, v26, v27
    v_cvt_pk_bf16_f32 v250, v28, v29
    v_cvt_pk_bf16_f32 v251, v30, v31
    buffer_store_dwordx4 v[248:251], v1, s[8:11], s81 offen sc1
    s_add_u32 s81, s81, 4096
    ds_write_b128 v13, v[248:251] offset:4096
    s_waitcnt vmcnt(16)
    v_cvt_f32_i32 v32, v32
    v_cvt_f32_i32 v33, v33
    v_cvt_f32_i32 v34, v34
    v_cvt_f32_i32 v35, v35
    v_cvt_f32_i32 v36, v36
    v_cvt_f32_i32 v37, v37
    v_cvt_f32_i32 v38, v38
    v_cvt_f32_i32 v39, v39
    v_cvt_pk_bf16_f32 v232, v32, v33
    v_cvt_pk_bf16_f32 v233, v34, v35
    v_cvt_pk_bf16_f32 v234, v36, v37
    v_cvt_pk_bf16_f32 v235, v38, v39
    v_lshlrev_b32 v32, 16, v232
    v_and_b32 v33, 0xffff0000, v232
    v_lshlrev_b32 v34, 16, v233
    v_and_b32 v35, 0xffff0000, v233
    v_lshlrev_b32 v36, 16, v234
    v_and_b32 v37, 0xffff0000, v234
    v_lshlrev_b32 v38, 16, v235
    v_and_b32 v39, 0xffff0000, v235
    v_pk_add_f32 v[32:33], v[32:33], v[224:225] neg_lo:[0,1] neg_hi:[0,1]
    v_pk_add_f32 v[34:35], v[34:35], v[226:227] neg_lo:[0,1] neg_hi:[0,1]
    v_pk_add_f32 v[36:37], v[36:37], v[228:229] neg_lo:[0,1] neg_hi:[0,1]
    v_pk_add_f32 v[38:39], v[38:39], v[230:231] neg_lo:[0,1] neg_hi:[0,1]
    v_cvt_pk_bf16_f32 v232, v32, v33
    v_cvt_pk_bf16_f32 v233, v34, v35
    v_cvt_pk_bf16_f32 v234, v36, v37
    v_cvt_pk_bf16_f32 v235, v38, v39
    v_lshlrev_b32 v32, 16, v232
    v_and_b32 v33, 0xffff0000, v232
    v_lshlrev_b32 v34, 16, v233
    v_and_b32 v35, 0xffff0000, v233
    v_lshlrev_b32 v36, 16, v234
    v_and_b32 v37, 0xffff0000, v234
    v_lshlrev_b32 v38, 16, v235
    v_and_b32 v39, 0xffff0000, v235
    v_pk_mul_f32 v[32:33], v[32:33], v[216:217]
    v_pk_mul_f32 v[34:35], v[34:35], v[218:219]
    v_pk_mul_f32 v[36:37], v[36:37], v[220:221]
    v_pk_mul_f32 v[38:39], v[38:39], v[222:223]
    v_cvt_pk_bf16_f32 v232, v32, v33
    v_cvt_pk_bf16_f32 v233, v34, v35
    v_cvt_pk_bf16_f32 v234, v36, v37
    v_cvt_pk_bf16_f32 v235, v38, v39
    v_lshlrev_b32 v32, 16, v232
    v_and_b32 v33, 0xffff0000, v232
    v_lshlrev_b32 v34, 16, v233
    v_and_b32 v35, 0xffff0000, v233
    v_lshlrev_b32 v36, 16, v234
    v_and_b32 v37, 0xffff0000, v234
    v_lshlrev_b32 v38, 16, v235
    v_and_b32 v39, 0xffff0000, v235
    v_pk_mul_f32 v[32:33], v[32:33], v[240:241]
    v_pk_mul_f32 v[34:35], v[34:35], v[240:241]
    v_pk_mul_f32 v[36:37], v[36:37], v[240:241]
    v_pk_mul_f32 v[38:39], v[38:39], v[240:241]
    v_cvt_pk_bf16_f32 v252, v32, v33
    v_cvt_pk_bf16_f32 v253, v34, v35
    v_cvt_pk_bf16_f32 v254, v36, v37
    v_cvt_pk_bf16_f32 v255, v38, v39
    buffer_store_dwordx4 v[252:255], v1, s[8:11], s81 offen sc1
    s_add_u32 s81, s81, 4096
    ds_write_b128 v13, v[252:255] offset:8192
    s_waitcnt vmcnt(15)
    v_cvt_f32_i32 v40, v40
    v_cvt_f32_i32 v41, v41
    v_cvt_f32_i32 v42, v42
    v_cvt_f32_i32 v43, v43
    v_cvt_f32_i32 v44, v44
    v_cvt_f32_i32 v45, v45
    v_cvt_f32_i32 v46, v46
    v_cvt_f32_i32 v47, v47
    v_cvt_pk_bf16_f32 v232, v40, v41
    v_cvt_pk_bf16_f32 v233, v42, v43
    v_cvt_pk_bf16_f32 v234, v44, v45
    v_cvt_pk_bf16_f32 v235, v46, v47
    v_lshlrev_b32 v40, 16, v232
    v_and_b32 v41, 0xffff0000, v232
    v_lshlrev_b32 v42, 16, v233
    v_and_b32 v43, 0xffff0000, v233
    v_lshlrev_b32 v44, 16, v234
    v_and_b32 v45, 0xffff0000, v234
    v_lshlrev_b32 v46, 16, v235
    v_and_b32 v47, 0xffff0000, v235
    v_pk_add_f32 v[40:41], v[40:41], v[224:225] neg_lo:[0,1] neg_hi:[0,1]
    v_pk_add_f32 v[42:43], v[42:43], v[226:227] neg_lo:[0,1] neg_hi:[0,1]
    v_pk_add_f32 v[44:45], v[44:45], v[228:229] neg_lo:[0,1] neg_hi:[0,1]
    v_pk_add_f32 v[46:47], v[46:47], v[230:231] neg_lo:[0,1] neg_hi:[0,1]
    v_cvt_pk_bf16_f32 v232, v40, v41
    v_cvt_pk_bf16_f32 v233, v42, v43
    v_cvt_pk_bf16_f32 v234, v44, v45
    v_cvt_pk_bf16_f32 v235, v46, v47
    v_lshlrev_b32 v40, 16, v232
    v_and_b32 v41, 0xffff0000, v232
    v_lshlrev_b32 v42, 16, v233
    v_and_b32 v43, 0xffff0000, v233
    v_lshlrev_b32 v44, 16, v234
    v_and_b32 v45, 0xffff0000, v234
    v_lshlrev_b32 v46, 16, v235
    v_and_b32 v47, 0xffff0000, v235
    v_pk_mul_f32 v[40:41], v[40:41], v[216:217]
    v_pk_mul_f32 v[42:43], v[42:43], v[218:219]
    v_pk_mul_f32 v[44:45], v[44:45], v[220:221]
    v_pk_mul_f32 v[46:47], v[46:47], v[222:223]
    v_cvt_pk_bf16_f32 v232, v40, v41
    v_cvt_pk_bf16_f32 v233, v42, v43
    v_cvt_pk_bf16_f32 v234, v44, v45
    v_cvt_pk_bf16_f32 v235, v46, v47
    v_lshlrev_b32 v40, 16, v232
    v_and_b32 v41, 0xffff0000, v232
    v_lshlrev_b32 v42, 16, v233
    v_and_b32 v43, 0xffff0000, v233
    v_lshlrev_b32 v44, 16, v234
    v_and_b32 v45, 0xffff0000, v234
    v_lshlrev_b32 v46, 16, v235
    v_and_b32 v47, 0xffff0000, v235
    v_pk_mul_f32 v[40:41], v[40:41], v[240:241]
    v_pk_mul_f32 v[42:43], v[42:43], v[240:241]
    v_pk_mul_f32 v[44:45], v[44:45], v[240:241]
    v_pk_mul_f32 v[46:47], v[46:47], v[240:241]
    v_cvt_pk_bf16_f32 v244, v40, v41
    v_cvt_pk_bf16_f32 v245, v42, v43
    v_cvt_pk_bf16_f32 v246, v44, v45
    v_cvt_pk_bf16_f32 v247, v46, v47
    buffer_store_dwordx4 v[244:247], v1, s[8:11], s81 offen sc1
    ds_write_b128 v13, v[244:247] offset:12288
    s_waitcnt vmcnt(12)
    v_lshlrev_b32 v216, 16, v184
    v_and_b32 v217, 0xffff0000, v184
    v_lshlrev_b32 v218, 16, v185
    v_and_b32 v219, 0xffff0000, v185
    v_lshlrev_b32 v220, 16, v186
    v_and_b32 v221, 0xffff0000, v186
    v_lshlrev_b32 v222, 16, v187
    v_and_b32 v223, 0xffff0000, v187
    v_lshlrev_b32 v224, 16, v188
    v_and_b32 v225, 0xffff0000, v188
    v_lshlrev_b32 v226, 16, v189
    v_and_b32 v227, 0xffff0000, v189
    v_lshlrev_b32 v228, 16, v190
    v_and_b32 v229, 0xffff0000, v190
    v_lshlrev_b32 v230, 16, v191
    v_and_b32 v231, 0xffff0000, v191
    s_waitcnt vmcnt(4)
    v_cvt_f32_i32 v48, v48
    v_cvt_f32_i32 v49, v49
    v_cvt_f32_i32 v50, v50
    v_cvt_f32_i32 v51, v51
    v_cvt_f32_i32 v52, v52
    v_cvt_f32_i32 v53, v53
    v_cvt_f32_i32 v54, v54
    v_cvt_f32_i32 v55, v55
    v_cvt_pk_bf16_f32 v232, v48, v49
    v_cvt_pk_bf16_f32 v233, v50, v51
    v_cvt_pk_bf16_f32 v234, v52, v53
    v_cvt_pk_bf16_f32 v235, v54, v55
    v_lshlrev_b32 v48, 16, v232
    v_and_b32 v49, 0xffff0000, v232
    v_lshlrev_b32 v50, 16, v233
    v_and_b32 v51, 0xffff0000, v233
    v_lshlrev_b32 v52, 16, v234
    v_and_b32 v53, 0xffff0000, v234
    v_lshlrev_b32 v54, 16, v235
    v_and_b32 v55, 0xffff0000, v235
    v_pk_add_f32 v[48:49], v[48:49], v[224:225] op_sel:[0,0] op_sel_hi:[1,0] neg_lo:[0,1] neg_hi:[0,1]
    v_pk_add_f32 v[50:51], v[50:51], v[224:225] op_sel:[0,0] op_sel_hi:[1,0] neg_lo:[0,1] neg_hi:[0,1]
    v_pk_add_f32 v[52:53], v[52:53], v[224:225] op_sel:[0,1] op_sel_hi:[1,1] neg_lo:[0,1] neg_hi:[0,1]
    v_pk_add_f32 v[54:55], v[54:55], v[224:225] op_sel:[0,1] op_sel_hi:[1,1] neg_lo:[0,1] neg_hi:[0,1]
    v_cvt_pk_bf16_f32 v232, v48, v49
    v_cvt_pk_bf16_f32 v233, v50, v51
    v_cvt_pk_bf16_f32 v234, v52, v53
    v_cvt_pk_bf16_f32 v235, v54, v55
    v_lshlrev_b32 v48, 16, v232
    v_and_b32 v49, 0xffff0000, v232
    v_lshlrev_b32 v50, 16, v233
    v_and_b32 v51, 0xffff0000, v233
    v_lshlrev_b32 v52, 16, v234
    v_and_b32 v53, 0xffff0000, v234
    v_lshlrev_b32 v54, 16, v235
    v_and_b32 v55, 0xffff0000, v235
    v_pk_mul_f32 v[48:49], v[48:49], v[216:217] op_sel:[0,0] op_sel_hi:[1,0]
    v_pk_mul_f32 v[50:51], v[50:51], v[216:217] op_sel:[0,0] op_sel_hi:[1,0]
    v_pk_mul_f32 v[52:53], v[52:53], v[216:217] op_sel:[0,1] op_sel_hi:[1,1]
    v_pk_mul_f32 v[54:55], v[54:55], v[216:217] op_sel:[0,1] op_sel_hi:[1,1]
    v_cvt_f32_i32 v56, v56
    v_cvt_f32_i32 v57, v57
    v_cvt_f32_i32 v58, v58
    v_cvt_f32_i32 v59, v59
    v_cvt_f32_i32 v60, v60
    v_cvt_f32_i32 v61, v61
    v_cvt_f32_i32 v62, v62
    v_cvt_f32_i32 v63, v63
    v_cvt_pk_bf16_f32 v232, v56, v57
    v_cvt_pk_bf16_f32 v233, v58, v59
    v_cvt_pk_bf16_f32 v234, v60, v61
    v_cvt_pk_bf16_f32 v235, v62, v63
    v_lshlrev_b32 v56, 16, v232
    v_and_b32 v57, 0xffff0000, v232
    v_lshlrev_b32 v58, 16, v233
    v_and_b32 v59, 0xffff0000, v233
    v_lshlrev_b32 v60, 16, v234
    v_and_b32 v61, 0xffff0000, v234
    v_lshlrev_b32 v62, 16, v235
    v_and_b32 v63, 0xffff0000, v235
    v_pk_add_f32 v[56:57], v[56:57], v[226:227] op_sel:[0,0] op_sel_hi:[1,0] neg_lo:[0,1] neg_hi:[0,1]
    v_pk_add_f32 v[58:59], v[58:59], v[226:227] op_sel:[0,0] op_sel_hi:[1,0] neg_lo:[0,1] neg_hi:[0,1]
    v_pk_add_f32 v[60:61], v[60:61], v[226:227] op_sel:[0,1] op_sel_hi:[1,1] neg_lo:[0,1] neg_hi:[0,1]
    v_pk_add_f32 v[62:63], v[62:63], v[226:227] op_sel:[0,1] op_sel_hi:[1,1] neg_lo:[0,1] neg_hi:[0,1]
    v_cvt_pk_bf16_f32 v232, v56, v57
    v_cvt_pk_bf16_f32 v233, v58, v59
    v_cvt_pk_bf16_f32 v234, v60, v61
    v_cvt_pk_bf16_f32 v235, v62, v63
    v_lshlrev_b32 v56, 16, v232
    v_and_b32 v57, 0xffff0000, v232
    v_lshlrev_b32 v58, 16, v233
    v_and_b32 v59, 0xffff0000, v233
    v_lshlrev_b32 v60, 16, v234
    v_and_b32 v61, 0xffff0000, v234
    v_lshlrev_b32 v62, 16, v235
    v_and_b32 v63, 0xffff0000, v235
    v_pk_mul_f32 v[56:57], v[56:57], v[218:219] op_sel:[0,0] op_sel_hi:[1,0]
    v_pk_mul_f32 v[58:59], v[58:59], v[218:219] op_sel:[0,0] op_sel_hi:[1,0]
    v_pk_mul_f32 v[60:61], v[60:61], v[218:219] op_sel:[0,1] op_sel_hi:[1,1]
    v_pk_mul_f32 v[62:63], v[62:63], v[218:219] op_sel:[0,1] op_sel_hi:[1,1]
    v_cvt_f32_i32 v64, v64
    v_cvt_f32_i32 v65, v65
    v_cvt_f32_i32 v66, v66
    v_cvt_f32_i32 v67, v67
    v_cvt_f32_i32 v68, v68
    v_cvt_f32_i32 v69, v69
    v_cvt_f32_i32 v70, v70
    v_cvt_f32_i32 v71, v71
    v_cvt_pk_bf16_f32 v232, v64, v65
    v_cvt_pk_bf16_f32 v233, v66, v67
    v_cvt_pk_bf16_f32 v234, v68, v69
    v_cvt_pk_bf16_f32 v235, v70, v71
    v_lshlrev_b32 v64, 16, v232
    v_and_b32 v65, 0xffff0000, v232
    v_lshlrev_b32 v66, 16, v233
    v_and_b32 v67, 0xffff0000, v233
    v_lshlrev_b32 v68, 16, v234
    v_and_b32 v69, 0xffff0000, v234
    v_lshlrev_b32 v70, 16, v235
    v_and_b32 v71, 0xffff0000, v235
    v_pk_add_f32 v[64:65], v[64:65], v[228:229] op_sel:[0,0] op_sel_hi:[1,0] neg_lo:[0,1] neg_hi:[0,1]
    v_pk_add_f32 v[66:67], v[66:67], v[228:229] op_sel:[0,0] op_sel_hi:[1,0] neg_lo:[0,1] neg_hi:[0,1]
    v_pk_add_f32 v[68:69], v[68:69], v[228:229] op_sel:[0,1] op_sel_hi:[1,1] neg_lo:[0,1] neg_hi:[0,1]
    v_pk_add_f32 v[70:71], v[70:71], v[228:229] op_sel:[0,1] op_sel_hi:[1,1] neg_lo:[0,1] neg_hi:[0,1]
    v_cvt_pk_bf16_f32 v232, v64, v65
    v_cvt_pk_bf16_f32 v233, v66, v67
    v_cvt_pk_bf16_f32 v234, v68, v69
    v_cvt_pk_bf16_f32 v235, v70, v71
    v_lshlrev_b32 v64, 16, v232
    v_and_b32 v65, 0xffff0000, v232
    v_lshlrev_b32 v66, 16, v233
    v_and_b32 v67, 0xffff0000, v233
    v_lshlrev_b32 v68, 16, v234
    v_and_b32 v69, 0xffff0000, v234
    v_lshlrev_b32 v70, 16, v235
    v_and_b32 v71, 0xffff0000, v235
    v_pk_mul_f32 v[64:65], v[64:65], v[220:221] op_sel:[0,0] op_sel_hi:[1,0]
    v_pk_mul_f32 v[66:67], v[66:67], v[220:221] op_sel:[0,0] op_sel_hi:[1,0]
    v_pk_mul_f32 v[68:69], v[68:69], v[220:221] op_sel:[0,1] op_sel_hi:[1,1]
    v_pk_mul_f32 v[70:71], v[70:71], v[220:221] op_sel:[0,1] op_sel_hi:[1,1]
    v_cvt_f32_i32 v72, v72
    v_cvt_f32_i32 v73, v73
    v_cvt_f32_i32 v74, v74
    v_cvt_f32_i32 v75, v75
    v_cvt_f32_i32 v76, v76
    v_cvt_f32_i32 v77, v77
    v_cvt_f32_i32 v78, v78
    v_cvt_f32_i32 v79, v79
    v_cvt_pk_bf16_f32 v232, v72, v73
    v_cvt_pk_bf16_f32 v233, v74, v75
    v_cvt_pk_bf16_f32 v234, v76, v77
    v_cvt_pk_bf16_f32 v235, v78, v79
    v_lshlrev_b32 v72, 16, v232
    v_and_b32 v73, 0xffff0000, v232
    v_lshlrev_b32 v74, 16, v233
    v_and_b32 v75, 0xffff0000, v233
    v_lshlrev_b32 v76, 16, v234
    v_and_b32 v77, 0xffff0000, v234
    v_lshlrev_b32 v78, 16, v235
    v_and_b32 v79, 0xffff0000, v235
    v_pk_add_f32 v[72:73], v[72:73], v[230:231] op_sel:[0,0] op_sel_hi:[1,0] neg_lo:[0,1] neg_hi:[0,1]
    v_pk_add_f32 v[74:75], v[74:75], v[230:231] op_sel:[0,0] op_sel_hi:[1,0] neg_lo:[0,1] neg_hi:[0,1]
    v_pk_add_f32 v[76:77], v[76:77], v[230:231] op_sel:[0,1] op_sel_hi:[1,1] neg_lo:[0,1] neg_hi:[0,1]
    v_pk_add_f32 v[78:79], v[78:79], v[230:231] op_sel:[0,1] op_sel_hi:[1,1] neg_lo:[0,1] neg_hi:[0,1]
    v_cvt_pk_bf16_f32 v232, v72, v73
    v_cvt_pk_bf16_f32 v233, v74, v75
    v_cvt_pk_bf16_f32 v234, v76, v77
    v_cvt_pk_bf16_f32 v235, v78, v79
    v_lshlrev_b32 v72, 16, v232
    v_and_b32 v73, 0xffff0000, v232
    v_lshlrev_b32 v74, 16, v233
    v_and_b32 v75, 0xffff0000, v233
    v_lshlrev_b32 v76, 16, v234
    v_and_b32 v77, 0xffff0000, v234
    v_lshlrev_b32 v78, 16, v235
    v_and_b32 v79, 0xffff0000, v235
    v_pk_mul_f32 v[72:73], v[72:73], v[222:223] op_sel:[0,0] op_sel_hi:[1,0]
    v_pk_mul_f32 v[74:75], v[74:75], v[222:223] op_sel:[0,0] op_sel_hi:[1,0]
    v_pk_mul_f32 v[76:77], v[76:77], v[222:223] op_sel:[0,1] op_sel_hi:[1,1]
    v_pk_mul_f32 v[78:79], v[78:79], v[222:223] op_sel:[0,1] op_sel_hi:[1,1]
    v_cvt_pk_bf16_f32 v248, v48, v52
    v_cvt_pk_bf16_f32 v249, v56, v60
    v_cvt_pk_bf16_f32 v250, v64, v68
    v_cvt_pk_bf16_f32 v251, v72, v76
    buffer_store_dwordx4 v[248:251], v1, s[8:11], s82 offen offset:0 sc1
    v_cvt_pk_bf16_f32 v252, v49, v53
    v_cvt_pk_bf16_f32 v253, v57, v61
    v_cvt_pk_bf16_f32 v254, v65, v69
    v_cvt_pk_bf16_f32 v255, v73, v77
    buffer_store_dwordx4 v[252:255], v1, s[8:11], s82 offen offset:1024 sc1
    v_cvt_pk_bf16_f32 v244, v50, v54
    v_cvt_pk_bf16_f32 v245, v58, v62
    v_cvt_pk_bf16_f32 v246, v66, v70
    v_cvt_pk_bf16_f32 v247, v74, v78
    buffer_store_dwordx4 v[244:247], v1, s[8:11], s82 offen offset:2048 sc1
    v_cvt_pk_bf16_f32 v248, v51, v55
    v_cvt_pk_bf16_f32 v249, v59, v63
    v_cvt_pk_bf16_f32 v250, v67, v71
    v_cvt_pk_bf16_f32 v251, v75, v79
    buffer_store_dwordx4 v[248:251], v1, s[8:11], s82 offen offset:3072 sc1
    buffer_load_dwordx4 a[128:131], v10, s[4:7], s88 offen offset:0 nt
    buffer_load_dwordx4 a[132:135], v10, s[4:7], s88 offen offset:64 nt
    buffer_load_dwordx4 a[136:139], v10, s[4:7], s88 offen offset:128 nt
    buffer_load_dwordx4 a[140:143], v10, s[4:7], s88 offen offset:192 nt
    buffer_load_dwordx4 a[144:147], v10, s[4:7], s89 offen offset:0 nt
    buffer_load_dwordx4 a[148:151], v10, s[4:7], s89 offen offset:64 nt
    buffer_load_dwordx4 a[152:155], v10, s[4:7], s89 offen offset:128 nt
    buffer_load_dwordx4 a[156:159], v10, s[4:7], s89 offen offset:192 nt
    buffer_load_dwordx4 a[160:163], v10, s[4:7], s90 offen offset:0 nt
    buffer_load_dwordx4 a[164:167], v10, s[4:7], s90 offen offset:64 nt
    buffer_load_dwordx4 a[168:171], v10, s[4:7], s90 offen offset:128 nt
    buffer_load_dwordx4 a[172:175], v10, s[4:7], s90 offen offset:192 nt
    buffer_load_dwordx4 a[176:179], v10, s[4:7], s91 offen offset:0 nt
    buffer_load_dwordx4 a[180:183], v10, s[4:7], s91 offen offset:64 nt
    buffer_load_dwordx4 a[184:187], v10, s[4:7], s91 offen offset:128 nt
    buffer_load_dwordx4 a[188:191], v10, s[4:7], s91 offen offset:192 nt
    v_mov_b32 v144, 0
    v_mov_b32 v145, 0
    v_mov_b32 v146, 0
    v_mov_b32 v147, 0
    s_waitcnt vmcnt(16) lgkmcnt(0)
    s_barrier
    s_cmp_lg_u32 s16, 0
    s_cbranch_scc1 L_noflag
    s_lshl_b32 s75, 1, s73
    v_mov_b32 v13, s75
    s_mov_b64 s[78:79], exec
    s_mov_b64 exec, 1
    buffer_atomic_or v13, v12, s[68:71], 0 offen sc1
    s_mov_b64 exec, s[78:79]
L_noflag:
    ds_read_b128 a[192:195], v3 offset:0
    ds_read_b128 a[196:199], v3 offset:1024
    ds_read_b128 a[200:203], v3 offset:2048
    ds_read_b128 a[204:207], v3 offset:3072
    ds_read_b128 a[208:211], v3 offset:4096
    ds_read_b128 a[212:215], v3 offset:5120
    ds_read_b128 a[216:219], v3 offset:6144
    ds_read_b128 a[220:223], v3 offset:7168
    ds_read_b128 a[224:227], v3 offset:8192
    ds_read_b128 a[228:231], v3 offset:9216
    ds_read_b128 a[232:235], v3 offset:10240
    ds_read_b128 a[236:239], v3 offset:11264
    ds_read_b128 a[240:243], v3 offset:12288
    ds_read_b128 a[244:247], v3 offset:13312
    ds_read_b128 a[248:251], v3 offset:14336
    ds_read_b128 a[252:255], v3 offset:15360
    s_waitcnt vmcnt(0) lgkmcnt(8)
    v_mfma_f32_16x16x32_bf16 v[16:19], a[192:195], a[128:131], 0
    v_mfma_f32_16x16x32_bf16 v[20:23], a[192:195], a[144:147], 0
    v_mfma_f32_16x16x32_bf16 v[24:27], a[192:195], a[160:163], 0
    v_mfma_f32_16x16x32_bf16 v[28:31], a[192:195], a[176:179], 0
    v_mfma_f32_16x16x32_bf16 v[16:19], a[196:199], a[132:135], v[16:19]
    v_mfma_f32_16x16x32_bf16 v[20:23], a[196:199], a[148:151], v[20:23]
    v_mfma_f32_16x16x32_bf16 v[24:27], a[196:199], a[164:167], v[24:27]
    v_mfma_f32_16x16x32_bf16 v[28:31], a[196:199], a[180:183], v[28:31]
    v_mfma_f32_16x16x32_bf16 v[16:19], a[200:203], a[136:139], v[16:19]
    v_mfma_f32_16x16x32_bf16 v[20:23], a[200:203], a[152:155], v[20:23]
    v_mfma_f32_16x16x32_bf16 v[24:27], a[200:203], a[168:171], v[24:27]
    v_mfma_f32_16x16x32_bf16 v[28:31], a[200:203], a[184:187], v[28:31]
    v_mfma_f32_16x16x32_bf16 v[16:19], a[204:207], a[140:143], v[16:19]
    v_mfma_f32_16x16x32_bf16 v[20:23], a[204:207], a[156:159], v[20:23]
    v_mfma_f32_16x16x32_bf16 v[24:27], a[204:207], a[172:175], v[24:27]
    v_mfma_f32_16x16x32_bf16 v[28:31], a[204:207], a[188:191], v[28:31]
    v_mfma_f32_16x16x32_bf16 v[32:35], a[208:211], a[128:131], 0
    v_mfma_f32_16x16x32_bf16 v[36:39], a[208:211], a[144:147], 0
    v_mfma_f32_16x16x32_bf16 v[40:43], a[208:211], a[160:163], 0
    v_mfma_f32_16x16x32_bf16 v[44:47], a[208:211], a[176:179], 0
    v_mfma_f32_16x16x32_bf16 v[32:35], a[212:215], a[132:135], v[32:35]
    v_mfma_f32_16x16x32_bf16 v[36:39], a[212:215], a[148:151], v[36:39]
    v_mfma_f32_16x16x32_bf16 v[40:43], a[212:215], a[164:167], v[40:43]
    v_mfma_f32_16x16x32_bf16 v[44:47], a[212:215], a[180:183], v[44:47]
    v_mfma_f32_16x16x32_bf16 v[32:35], a[216:219], a[136:139], v[32:35]
    v_mfma_f32_16x16x32_bf16 v[36:39], a[216:219], a[152:155], v[36:39]
    v_mfma_f32_16x16x32_bf16 v[40:43], a[216:219], a[168:171], v[40:43]
    v_mfma_f32_16x16x32_bf16 v[44:47], a[216:219], a[184:187], v[44:47]
    v_mfma_f32_16x16x32_bf16 v[32:35], a[220:223], a[140:143], v[32:35]
    v_mfma_f32_16x16x32_bf16 v[36:39], a[220:223], a[156:159], v[36:39]
    v_mfma_f32_16x16x32_bf16 v[40:43], a[220:223], a[172:175], v[40:43]
    v_mfma_f32_16x16x32_bf16 v[44:47], a[220:223], a[188:191], v[44:47]
    s_nop 7
    v_max3_f32 v150, v16, v17, v18
    v_max3_f32 v150, v150, v19, v32
    v_max3_f32 v150, v150, v33, v34
    v_max_f32 v150, v150, v35
    v_mov_b32 v158, v150
    s_nop 1
    v_permlane16_swap_b32 v150, v158
    v_max_f32 v150, v150, v158
    v_mov_b32 v158, v150
    s_nop 1
    v_permlane32_swap_b32 v150, v158
    v_max_f32 v150, v150, v158
    v_max3_f32 v151, v20, v21, v22
    v_max3_f32 v151, v151, v23, v36
    v_max3_f32 v151, v151, v37, v38
    v_max_f32 v151, v151, v39
    v_mov_b32 v158, v151
    s_nop 1
    v_permlane16_swap_b32 v151, v158
    v_max_f32 v151, v151, v158
    v_mov_b32 v158, v151
    s_nop 1
    v_permlane32_swap_b32 v151, v158
    v_max_f32 v151, v151, v158
    v_max3_f32 v152, v24, v25, v26
    v_max3_f32 v152, v152, v27, v40
    v_max3_f32 v152, v152, v41, v42
    v_max_f32 v152, v152, v43
    v_mov_b32 v158, v152
    s_nop 1
    v_permlane16_swap_b32 v152, v158
    v_max_f32 v152, v152, v158
    v_mov_b32 v158, v152
    s_nop 1
    v_permlane32_swap_b32 v152, v158
    v_max_f32 v152, v152, v158
    v_max3_f32 v153, v28, v29, v30
    v_max3_f32 v153, v153, v31, v44
    v_max3_f32 v153, v153, v45, v46
    v_max_f32 v153, v153, v47
    v_mov_b32 v158, v153
    s_nop 1
    v_permlane16_swap_b32 v153, v158
    v_max_f32 v153, v153, v158
    v_mov_b32 v158, v153
    s_nop 1
    v_permlane32_swap_b32 v153, v158
    v_max_f32 v153, v153, v158
    v_sub_f32 v112, 0, v150
    v_sub_f32 v113, 0, v150
    v_sub_f32 v114, 0, v150
    v_sub_f32 v115, 0, v150
    v_sub_f32 v16, v16, v150
    v_sub_f32 v17, v17, v150
    v_sub_f32 v18, v18, v150
    v_sub_f32 v19, v19, v150
    v_sub_f32 v32, v32, v150
    v_sub_f32 v33, v33, v150
    v_sub_f32 v34, v34, v150
    v_sub_f32 v35, v35, v150
    v_sub_f32 v116, 0, v151
    v_sub_f32 v117, 0, v151
    v_sub_f32 v118, 0, v151
    v_sub_f32 v119, 0, v151
    v_sub_f32 v20, v20, v151
    v_sub_f32 v21, v21, v151
    v_sub_f32 v22, v22, v151
    v_sub_f32 v23, v23, v151
    v_sub_f32 v36, v36, v151
    v_sub_f32 v37, v37, v151
    v_sub_f32 v38, v38, v151
    v_sub_f32 v39, v39, v151
    v_sub_f32 v120, 0, v152
    v_sub_f32 v121, 0, v152
    v_sub_f32 v122, 0, v152
    v_sub_f32 v123, 0, v152
    v_sub_f32 v24, v24, v152
    v_sub_f32 v25, v25, v152
    v_sub_f32 v26, v26, v152
    v_sub_f32 v27, v27, v152
    v_sub_f32 v40, v40, v152
    v_sub_f32 v41, v41, v152
    v_sub_f32 v42, v42, v152
    v_sub_f32 v43, v43, v152
    v_sub_f32 v124, 0, v153
    v_sub_f32 v125, 0, v153
    v_sub_f32 v126, 0, v153
    v_sub_f32 v127, 0, v153
    v_sub_f32 v28, v28, v153
    v_sub_f32 v29, v29, v153
    v_sub_f32 v30, v30, v153
    v_sub_f32 v31, v31, v153
    v_sub_f32 v44, v44, v153
    v_sub_f32 v45, v45, v153
    v_sub_f32 v46, v46, v153
    v_sub_f32 v47, v47, v153
    s_waitcnt lgkmcnt(0)
    v_mfma_f32_16x16x32_bf16 v[48:51], a[224:227], a[128:131], v[112:115]
    v_exp_f32 v128, v16
    v_exp_f32 v129, v17
    v_mfma_f32_16x16x32_bf16 v[52:55], a[224:227], a[144:147], v[116:119]
    v_add_f32 v136, v128, v129
    v_cvt_pk_bf16_f32 v80, v128, v129
    v_mfma_f32_16x16x32_bf16 v[56:59], a[224:227], a[160:163], v[120:123]
    v_exp_f32 v130, v18
    v_exp_f32 v131, v19
    v_mfma_f32_16x16x32_bf16 v[60:63], a[224:227], a[176:179], v[124:127]
    v_add_f32 v136, v136, v130
    v_add_f32 v136, v136, v131
    v_cvt_pk_bf16_f32 v81, v130, v131
    v_mfma_f32_16x16x32_bf16 v[48:51], a[228:231], a[132:135], v[48:51]
    v_exp_f32 v132, v20
    v_exp_f32 v133, v21
    v_mfma_f32_16x16x32_bf16 v[52:55], a[228:231], a[148:151], v[52:55]
    v_add_f32 v137, v132, v133
    v_cvt_pk_bf16_f32 v84, v132, v133
    v_mfma_f32_16x16x32_bf16 v[56:59], a[228:231], a[164:167], v[56:59]
    v_exp_f32 v134, v22
    v_exp_f32 v135, v23
    v_mfma_f32_16x16x32_bf16 v[60:63], a[228:231], a[180:183], v[60:63]
    v_add_f32 v137, v137, v134
    v_add_f32 v137, v137, v135
    v_cvt_pk_bf16_f32 v85, v134, v135
    v_mfma_f32_16x16x32_bf16 v[48:51], a[232:235], a[136:139], v[48:51]
    v_exp_f32 v128, v24
    v_exp_f32 v129, v25
    v_mfma_f32_16x16x32_bf16 v[52:55], a[232:235], a[152:155], v[52:55]
    v_add_f32 v138, v128, v129
    v_cvt_pk_bf16_f32 v88, v128, v129
    v_mfma_f32_16x16x32_bf16 v[56:59], a[232:235], a[168:171], v[56:59]
    v_exp_f32 v130, v26
    v_exp_f32 v131, v27
    v_mfma_f32_16x16x32_bf16 v[60:63], a[232:235], a[184:187], v[60:63]
    v_add_f32 v138, v138, v130
    v_add_f32 v138, v138, v131
    v_cvt_pk_bf16_f32 v89, v130, v131
    v_mfma_f32_16x16x32_bf16 v[48:51], a[236:239], a[140:143], v[48:51]
    v_exp_f32 v132, v28
    v_exp_f32 v133, v29
    v_mfma_f32_16x16x32_bf16 v[52:55], a[236:239], a[156:159], v[52:55]
    v_add_f32 v139, v132, v133
    v_cvt_pk_bf16_f32 v92, v132, v133
    v_mfma_f32_16x16x32_bf16 v[56:59], a[236:239], a[172:175], v[56:59]
    v_exp_f32 v134, v30
    v_exp_f32 v135, v31
    v_mfma_f32_16x16x32_bf16 v[60:63], a[236:239], a[188:191], v[60:63]
    v_add_f32 v139, v139, v134
    v_add_f32 v139, v139, v135
    v_cvt_pk_bf16_f32 v93, v134, v135
    v_mfma_f32_16x16x32_bf16 v[64:67], a[240:243], a[128:131], v[112:115]
    v_exp_f32 v128, v32
    v_exp_f32 v129, v33
    v_mfma_f32_16x16x32_bf16 v[68:71], a[240:243], a[144:147], v[116:119]
    v_add_f32 v136, v136, v128
    v_add_f32 v136, v136, v129
    v_cvt_pk_bf16_f32 v82, v128, v129
    v_mfma_f32_16x16x32_bf16 v[72:75], a[240:243], a[160:163], v[120:123]
    v_exp_f32 v130, v34
    v_exp_f32 v131, v35
    v_mfma_f32_16x16x32_bf16 v[76:79], a[240:243], a[176:179], v[124:127]
    v_add_f32 v136, v136, v130
    v_add_f32 v136, v136, v131
    v_cvt_pk_bf16_f32 v83, v130, v131
    v_mfma_f32_16x16x32_bf16 v[64:67], a[244:247], a[132:135], v[64:67]
    v_exp_f32 v132, v36
    v_exp_f32 v133, v37
    v_mfma_f32_16x16x32_bf16 v[68:71], a[244:247], a[148:151], v[68:71]
    v_add_f32 v137, v137, v132
    v_add_f32 v137, v137, v133
    v_cvt_pk_bf16_f32 v86, v132, v133
    v_mfma_f32_16x16x32_bf16 v[72:75], a[244:247], a[164:167], v[72:75]
    v_exp_f32 v134, v38
    v_exp_f32 v135, v39
    v_mfma_f32_16x16x32_bf16 v[76:79], a[244:247], a[180:183], v[76:79]
    v_add_f32 v137, v137, v134
    v_add_f32 v137, v137, v135
    v_cvt_pk_bf16_f32 v87, v134, v135
    v_mfma_f32_16x16x32_bf16 v[64:67], a[248:251], a[136:139], v[64:67]
    v_exp_f32 v128, v40
    v_exp_f32 v129, v41
    v_mfma_f32_16x16x32_bf16 v[68:71], a[248:251], a[152:155], v[68:71]
    v_add_f32 v138, v138, v128
    v_add_f32 v138, v138, v129
    v_cvt_pk_bf16_f32 v90, v128, v129
    v_mfma_f32_16x16x32_bf16 v[72:75], a[248:251], a[168:171], v[72:75]
    v_exp_f32 v130, v42
    v_exp_f32 v131, v43
    v_mfma_f32_16x16x32_bf16 v[76:79], a[248:251], a[184:187], v[76:79]
    v_add_f32 v138, v138, v130
    v_add_f32 v138, v138, v131
    v_cvt_pk_bf16_f32 v91, v130, v131
    v_mfma_f32_16x16x32_bf16 v[64:67], a[252:255], a[140:143], v[64:67]
    v_exp_f32 v132, v44
    v_exp_f32 v133, v45
    v_mfma_f32_16x16x32_bf16 v[68:71], a[252:255], a[156:159], v[68:71]
    v_add_f32 v139, v139, v132
    v_add_f32 v139, v139, v133
    v_cvt_pk_bf16_f32 v94, v132, v133
    v_mfma_f32_16x16x32_bf16 v[72:75], a[252:255], a[172:175], v[72:75]
    v_exp_f32 v134, v46
    v_exp_f32 v135, v47
    v_mfma_f32_16x16x32_bf16 v[76:79], a[252:255], a[188:191], v[76:79]
    v_add_f32 v139, v139, v134
    v_add_f32 v139, v139, v135
    v_cvt_pk_bf16_f32 v95, v134, v135
    v_exp_f32 v128, v48
    v_exp_f32 v129, v49
    s_cmp_lg_u32 s16, 0
    s_cbranch_scc1 L_nopoll
    s_mov_b64 s[78:79], exec
    s_mov_b64 exec, 1
    s_mov_b32 s77, 0
L_poll:
    buffer_load_dword v13, v12, s[68:71], 0 offen sc1
    s_waitcnt vmcnt(0)
    v_readfirstlane_b32 s75, v13
    s_nop 1
    s_cmp_eq_u32 s75, -1
    s_cbranch_scc1 L_polled
    s_sleep 12
    s_add_u32 s77, s77, 1
    s_cmp_lt_u32 s77, 20000
    s_cbranch_scc1 L_poll
L_polled:
    ds_write_b32 v14, v13
    s_mov_b64 exec, s[78:79]
    s_waitcnt lgkmcnt(0)
L_nopoll:
    s_barrier
    ds_read_b32 v13, v14
    s_waitcnt lgkmcnt(0)
    v_readfirstlane_b32 s17, v13
    s_nop 1
    s_cmp_lg_u32 s17, -1
    s_cbranch_scc1 L_fb
L_ready:
    s_add_u32 s19, s23, s22
    s_add_u32 s21, s19, 4096
    s_add_u32 s22, s22, 16384
    s_and_b32 s22, s22, 0x7ffff
    s_add_u32 m0, s20, 0
    s_nop 0
    buffer_load_dwordx4 v1, s[8:11], s19 offen offset:0 sc1 lds
    buffer_load_dwordx4 v1, s[8:11], s19 offen offset:1024 sc1 lds
    buffer_load_dwordx4 v1, s[8:11], s19 offen offset:2048 sc1 lds
    buffer_load_dwordx4 v1, s[8:11], s19 offen offset:3072 sc1 lds
    s_add_u32 m0, s20, 4096
    s_nop 0
    buffer_load_dwordx4 v1, s[8:11], s21 offen offset:0 sc1 lds
    buffer_load_dwordx4 v1, s[8:11], s21 offen offset:1024 sc1 lds
    buffer_load_dwordx4 v1, s[8:11], s21 offen offset:2048 sc1 lds
    buffer_load_dwordx4 v1, s[8:11], s21 offen offset:3072 sc1 lds
    s_add_u32 s19, s23, s22
    s_add_u32 s21, s19, 4096
    s_add_u32 s22, s22, 16384
    s_and_b32 s22, s22, 0x7ffff
    s_add_u32 m0, s20, 32768
    s_nop 0
    buffer_load_dwordx4 v1, s[8:11], s19 offen offset:0 sc1 lds
    buffer_load_dwordx4 v1, s[8:11], s19 offen offset:1024 sc1 lds
    buffer_load_dwordx4 v1, s[8:11], s19 offen offset:2048 sc1 lds
    buffer_load_dwordx4 v1, s[8:11], s19 offen offset:3072 sc1 lds
    s_add_u32 m0, s20, 36864
    s_nop 0
    buffer_load_dwordx4 v1, s[8:11], s21 offen offset:0 sc1 lds
    buffer_load_dwordx4 v1, s[8:11], s21 offen offset:1024 sc1 lds
    buffer_load_dwordx4 v1, s[8:11], s21 offen offset:2048 sc1 lds
    buffer_load_dwordx4 v1, s[8:11], s21 offen offset:3072 sc1 lds
    s_waitcnt vmcnt(8)
    s_barrier
    ds_read_b128 a[192:195], v1 offset:0
    ds_read_b128 a[196:199], v1 offset:1024
    ds_read_b128 a[200:203], v1 offset:2048
    ds_read_b128 a[204:207], v1 offset:3072
    ds_read_b128 a[208:211], v1 offset:4096
    ds_read_b128 a[212:215], v1 offset:5120
    ds_read_b128 a[216:219], v1 offset:6144
    s_waitcnt lgkmcnt(6)
    v_mfma_f32_16x16x32_bf16 a[0:3], a[192:195], v[80:83], a[0:3]
    ds_read_b128 a[220:223], v1 offset:7168
    v_add_f32 v140, v128, v129
    v_mfma_f32_16x16x32_bf16 a[4:7], a[192:195], v[84:87], a[4:7]
    v_exp_f32 v130, v50
    v_add_f32 v144, v144, v136
    v_mfma_f32_16x16x32_bf16 a[8:11], a[192:195], v[88:91], a[8:11]
    v_cvt_pk_bf16_f32 v96, v128, v129
    v_add_f32 v140, v140, v130
    v_mfma_f32_16x16x32_bf16 a[12:15], a[192:195], v[92:95], a[12:15]
    s_waitcnt lgkmcnt(6)
    v_exp_f32 v131, v51
    v_mfma_f32_16x16x32_bf16 a[16:19], a[196:199], v[80:83], a[16:19]
    ds_read_b128 a[192:195], v1 offset:8192
    v_add_f32 v140, v140, v131
    v_mfma_f32_16x16x32_bf16 a[20:23], a[196:199], v[84:87], a[20:23]
    v_exp_f32 v132, v52
    v_mfma_f32_16x16x32_bf16 a[24:27], a[196:199], v[88:91], a[24:27]
    v_cvt_pk_bf16_f32 v97, v130, v131
    v_add_f32 v145, v145, v137
    v_mfma_f32_16x16x32_bf16 a[28:31], a[196:199], v[92:95], a[28:31]
    s_waitcnt lgkmcnt(6)
    v_exp_f32 v133, v53
    v_mfma_f32_16x16x32_bf16 a[32:35], a[200:203], v[80:83], a[32:35]
    ds_read_b128 a[196:199], v1 offset:9216
    v_add_f32 v141, v132, v133
    v_mfma_f32_16x16x32_bf16 a[36:39], a[200:203], v[84:87], a[36:39]
    v_exp_f32 v134, v54
    v_mfma_f32_16x16x32_bf16 a[40:43], a[200:203], v[88:91], a[40:43]
    v_cvt_pk_bf16_f32 v100, v132, v133
    v_add_f32 v141, v141, v134
    v_mfma_f32_16x16x32_bf16 a[44:47], a[200:203], v[92:95], a[44:47]
    s_waitcnt lgkmcnt(6)
    v_exp_f32 v135, v55
    v_mfma_f32_16x16x32_bf16 a[48:51], a[204:207], v[80:83], a[48:51]
    ds_read_b128 a[200:203], v1 offset:10240
    v_add_f32 v141, v141, v135
    v_mfma_f32_16x16x32_bf16 a[52:55], a[204:207], v[84:87], a[52:55]
    v_exp_f32 v128, v56
    v_mfma_f32_16x16x32_bf16 a[56:59], a[204:207], v[88:91], a[56:59]
    v_cvt_pk_bf16_f32 v101, v134, v135
    v_add_f32 v146, v146, v138
    v_mfma_f32_16x16x32_bf16 a[60:63], a[204:207], v[92:95], a[60:63]
    s_waitcnt lgkmcnt(6)
    v_exp_f32 v129, v57
    v_mfma_f32_16x16x32_bf16 a[64:67], a[208:211], v[80:83], a[64:67]
    ds_read_b128 a[204:207], v1 offset:11264
    v_add_f32 v142, v128, v129
    v_mfma_f32_16x16x32_bf16 a[68:71], a[208:211], v[84:87], a[68:71]
    v_exp_f32 v130, v58
    v_mfma_f32_16x16x32_bf16 a[72:75], a[208:211], v[88:91], a[72:75]
    v_cvt_pk_bf16_f32 v104, v128, v129
    v_add_f32 v142, v142, v130
    v_mfma_f32_16x16x32_bf16 a[76:79], a[208:211], v[92:95], a[76:79]
    s_waitcnt lgkmcnt(6)
    v_exp_f32 v131, v59
    v_mfma_f32_16x16x32_bf16 a[80:83], a[212:215], v[80:83], a[80:83]
    ds_read_b128 a[208:211], v1 offset:12288
    v_add_f32 v142, v142, v131
    v_mfma_f32_16x16x32_bf16 a[84:87], a[212:215], v[84:87], a[84:87]
    v_exp_f32 v132, v60
    v_mfma_f32_16x16x32_bf16 a[88:91], a[212:215], v[88:91], a[88:91]
    v_cvt_pk_bf16_f32 v105, v130, v131
    v_add_f32 v147, v147, v139
    v_mfma_f32_16x16x32_bf16 a[92:95], a[212:215], v[92:95], a[92:95]
    s_waitcnt lgkmcnt(6)
    v_exp_f32 v133, v61
    v_mfma_f32_16x16x32_bf16 a[96:99], a[216:219], v[80:83], a[96:99]
    ds_read_b128 a[212:215], v1 offset:13312
    v_add_f32 v143, v132, v133
    v_mfma_f32_16x16x32_bf16 a[100:103], a[216:219], v[84:87], a[100:103]
    v_exp_f32 v134, v62
    v_mfma_f32_16x16x32_bf16 a[104:107], a[216:219], v[88:91], a[104:107]
    v_cvt_pk_bf16_f32 v108, v132, v133
    v_add_f32 v143, v143, v134
    v_mfma_f32_16x16x32_bf16 a[108:111], a[216:219], v[92:95], a[108:111]
    s_waitcnt lgkmcnt(6)
    v_exp_f32 v135, v63
    v_mfma_f32_16x16x32_bf16 a[112:115], a[220:223], v[80:83], a[112:115]
    ds_read_b128 a[216:219], v1 offset:14336
    v_add_f32 v143, v143, v135
    v_mfma_f32_16x16x32_bf16 a[116:119], a[220:223], v[84:87], a[116:119]
    v_exp_f32 v128, v64
    v_mfma_f32_16x16x32_bf16 a[120:123], a[220:223], v[88:91], a[120:123]
    v_cvt_pk_bf16_f32 v109, v134, v135
    v_add_f32 v140, v140, v128
    v_mfma_f32_16x16x32_bf16 a[124:127], a[220:223], v[92:95], a[124:127]
    s_waitcnt lgkmcnt(6)
    v_exp_f32 v129, v65
    v_mfma_f32_16x16x32_bf16 v[16:19], a[192:195], a[128:131], v[112:115]
    ds_read_b128 a[220:223], v1 offset:15360
    v_add_f32 v140, v140, v129
    v_mfma_f32_16x16x32_bf16 v[20:23], a[192:195], a[144:147], v[116:119]
    v_exp_f32 v130, v66
    v_mfma_f32_16x16x32_bf16 v[24:27], a[192:195], a[160:163], v[120:123]
    v_cvt_pk_bf16_f32 v98, v128, v129
    v_add_f32 v140, v140, v130
    v_mfma_f32_16x16x32_bf16 v[28:31], a[192:195], a[176:179], v[124:127]
    s_waitcnt lgkmcnt(6)
    v_exp_f32 v131, v67
    v_mfma_f32_16x16x32_bf16 v[16:19], a[196:199], a[132:135], v[16:19]
    ds_read_b128 a[192:195], v1 offset:16384
    v_add_f32 v140, v140, v131
    v_mfma_f32_16x16x32_bf16 v[20:23], a[196:199], a[148:151], v[20:23]
    v_exp_f32 v132, v68
    v_mfma_f32_16x16x32_bf16 v[24:27], a[196:199], a[164:167], v[24:27]
    v_cvt_pk_bf16_f32 v99, v130, v131
    v_add_f32 v141, v141, v132
    v_mfma_f32_16x16x32_bf16 v[28:31], a[196:199], a[180:183], v[28:31]
    s_waitcnt lgkmcnt(6)
    v_exp_f32 v133, v69
    v_mfma_f32_16x16x32_bf16 v[16:19], a[200:203], a[136:139], v[16:19]
    ds_read_b128 a[196:199], v1 offset:17408
    v_add_f32 v141, v141, v133
    v_mfma_f32_16x16x32_bf16 v[20:23], a[200:203], a[152:155], v[20:23]
    v_exp_f32 v134, v70
    v_mfma_f32_16x16x32_bf16 v[24:27], a[200:203], a[168:171], v[24:27]
    v_cvt_pk_bf16_f32 v102, v132, v133
    v_add_f32 v141, v141, v134
    v_mfma_f32_16x16x32_bf16 v[28:31], a[200:203], a[184:187], v[28:31]
    s_waitcnt lgkmcnt(6)
    v_exp_f32 v135, v71
    v_mfma_f32_16x16x32_bf16 v[16:19], a[204:207], a[140:143], v[16:19]
    ds_read_b128 a[200:203], v1 offset:18432
    v_add_f32 v141, v141, v135
    v_mfma_f32_16x16x32_bf16 v[20:23], a[204:207], a[156:159], v[20:23]
    v_exp_f32 v128, v72
    v_mfma_f32_16x16x32_bf16 v[24:27], a[204:207], a[172:175], v[24:27]
    v_cvt_pk_bf16_f32 v103, v134, v135
    v_add_f32 v142, v142, v128
    v_mfma_f32_16x16x32_bf16 v[28:31], a[204:207], a[188:191], v[28:31]
    s_waitcnt lgkmcnt(6)
    v_exp_f32 v129, v73
    v_mfma_f32_16x16x32_bf16 v[32:35], a[208:211], a[128:131], v[112:115]
    ds_read_b128 a[204:207], v1 offset:19456
    v_add_f32 v142, v142, v129
    v_mfma_f32_16x16x32_bf16 v[36:39], a[208:211], a[144:147], v[116:119]
    v_exp_f32 v130, v74
    v_mfma_f32_16x16x32_bf16 v[40:43], a[208:211], a[160:163], v[120:123]
    v_cvt_pk_bf16_f32 v106, v128, v129
    v_add_f32 v142, v142, v130
    v_mfma_f32_16x16x32_bf16 v[44:47], a[208:211], a[176:179], v[124:127]
    s_waitcnt lgkmcnt(6)
    v_exp_f32 v131, v75
    v_mfma_f32_16x16x32_bf16 v[32:35], a[212:215], a[132:135], v[32:35]
    ds_read_b128 a[208:211], v1 offset:20480
    v_add_f32 v142, v142, v131
    v_mfma_f32_16x16x32_bf16 v[36:39], a[212:215], a[148:151], v[36:39]
    v_exp_f32 v132, v76
    v_mfma_f32_16x16x32_bf16 v[40:43], a[212:215], a[164:167], v[40:43]
    v_cvt_pk_bf16_f32 v107, v130, v131
    v_add_f32 v143, v143, v132
    v_mfma_f32_16x16x32_bf16 v[44:47], a[212:215], a[180:183], v[44:47]
    s_waitcnt lgkmcnt(6)
    v_exp_f32 v133, v77
    v_mfma_f32_16x16x32_bf16 v[32:35], a[216:219], a[136:139], v[32:35]
    ds_read_b128 a[212:215], v1 offset:21504
    v_add_f32 v143, v143, v133
    v_mfma_f32_16x16x32_bf16 v[36:39], a[216:219], a[152:155], v[36:39]
    v_exp_f32 v134, v78
    v_max3_f32 v148, v140, v141, v142
    v_mfma_f32_16x16x32_bf16 v[40:43], a[216:219], a[168:171], v[40:43]
    v_cvt_pk_bf16_f32 v110, v132, v133
    v_add_f32 v143, v143, v134
    v_mfma_f32_16x16x32_bf16 v[44:47], a[216:219], a[184:187], v[44:47]
    s_waitcnt lgkmcnt(6)
    v_exp_f32 v135, v79
    v_mfma_f32_16x16x32_bf16 v[32:35], a[220:223], a[140:143], v[32:35]
    ds_read_b128 a[216:219], v1 offset:22528
    v_add_f32 v143, v143, v135
    v_mfma_f32_16x16x32_bf16 v[36:39], a[220:223], a[156:159], v[36:39]
    v_exp_f32 v128, v16
    v_max_f32 v148, v148, v143
    v_mfma_f32_16x16x32_bf16 v[40:43], a[220:223], a[172:175], v[40:43]
    v_cvt_pk_bf16_f32 v111, v134, v135
    v_cmp_lt_f32 vcc, s18, v148
    v_mfma_f32_16x16x32_bf16 v[44:47], a[220:223], a[188:191], v[44:47]
    s_waitcnt lgkmcnt(6)
    s_cbranch_vccnz L_tramp_0
L_back_0:
    v_exp_f32 v129, v17
    v_mfma_f32_16x16x32_bf16 a[0:3], a[192:195], v[96:99], a[0:3]
    ds_read_b128 a[220:223], v1 offset:23552
    v_add_f32 v136, v128, v129
    v_mfma_f32_16x16x32_bf16 a[4:7], a[192:195], v[100:103], a[4:7]
    v_exp_f32 v130, v18
    v_add_f32 v144, v144, v140
    v_mfma_f32_16x16x32_bf16 a[8:11], a[192:195], v[104:107], a[8:11]
    v_cvt_pk_bf16_f32 v80, v128, v129
    v_add_f32 v136, v136, v130
    v_mfma_f32_16x16x32_bf16 a[12:15], a[192:195], v[108:111], a[12:15]
    s_waitcnt lgkmcnt(6)
    v_exp_f32 v131, v19
    v_mfma_f32_16x16x32_bf16 a[16:19], a[196:199], v[96:99], a[16:19]
    ds_read_b128 a[192:195], v1 offset:24576
    v_add_f32 v136, v136, v131
    v_mfma_f32_16x16x32_bf16 a[20:23], a[196:199], v[100:103], a[20:23]
    v_exp_f32 v132, v20
    v_mfma_f32_16x16x32_bf16 a[24:27], a[196:199], v[104:107], a[24:27]
    v_cvt_pk_bf16_f32 v81, v130, v131
    v_add_f32 v145, v145, v141
    v_mfma_f32_16x16x32_bf16 a[28:31], a[196:199], v[108:111], a[28:31]
    s_waitcnt lgkmcnt(6)
    v_exp_f32 v133, v21
    v_mfma_f32_16x16x32_bf16 a[32:35], a[200:203], v[96:99], a[32:35]
    ds_read_b128 a[196:199], v1 offset:25600
    v_add_f32 v137, v132, v133
    v_mfma_f32_16x16x32_bf16 a[36:39], a[200:203], v[100:103], a[36:39]
    v_exp_f32 v134, v22
    v_mfma_f32_16x16x32_bf16 a[40:43], a[200:203], v[104:107], a[40:43]
    v_cvt_pk_bf16_f32 v84, v132, v133
    v_add_f32 v137, v137, v134
    v_mfma_f32_16x16x32_bf16 a[44:47], a[200:203], v[108:111], a[44:47]
    s_waitcnt lgkmcnt(6)
    v_exp_f32 v135, v23
    v_mfma_f32_16x16x32_bf16 a[48:51], a[204:207], v[96:99], a[48:51]
    ds_read_b128 a[200:203], v1 offset:26624
    v_add_f32 v137, v137, v135
    v_mfma_f32_16x16x32_bf16 a[52:55], a[204:207], v[100:103], a[52:55]
    v_exp_f32 v128, v24
    v_mfma_f32_16x16x32_bf16 a[56:59], a[204:207], v[104:107], a[56:59]
    v_cvt_pk_bf16_f32 v85, v134, v135
    v_add_f32 v146, v146, v142
    v_mfma_f32_16x16x32_bf16 a[60:63], a[204:207], v[108:111], a[60:63]
    s_waitcnt lgkmcnt(6)
    v_exp_f32 v129, v25
    v_mfma_f32_16x16x32_bf16 a[64:67], a[208:211], v[96:99], a[64:67]
    ds_read_b128 a[204:207], v1 offset:27648
    v_add_f32 v138, v128, v129
    v_mfma_f32_16x16x32_bf16 a[68:71], a[208:211], v[100:103], a[68:71]
    v_exp_f32 v130, v26
    v_mfma_f32_16x16x32_bf16 a[72:75], a[208:211], v[104:107], a[72:75]
    s_waitcnt vmcnt(0)
    s_barrier
    v_cvt_pk_bf16_f32 v88, v128, v129
    v_add_f32 v138, v138, v130
    v_mfma_f32_16x16x32_bf16 a[76:79], a[208:211], v[108:111], a[76:79]
    s_waitcnt lgkmcnt(6)
    v_exp_f32 v131, v27
    v_mfma_f32_16x16x32_bf16 a[80:83], a[212:215], v[96:99], a[80:83]
    s_add_u32 s19, s23, s22
    s_add_u32 s21, s19, 4096
    s_add_u32 s22, s22, 16384
    s_and_b32 s22, s22, 0x7ffff
    s_add_u32 m0, s20, 65536
    ds_read_b128 a[208:211], v1 offset:28672
    v_add_f32 v138, v138, v131
    v_mfma_f32_16x16x32_bf16 a[84:87], a[212:215], v[100:103], a[84:87]
    buffer_load_dwordx4 v1, s[8:11], s19 offen offset:0 sc1 lds
    v_exp_f32 v132, v28
    v_mfma_f32_16x16x32_bf16 a[88:91], a[212:215], v[104:107], a[88:91]
    v_cvt_pk_bf16_f32 v89, v130, v131
    v_add_f32 v147, v147, v143
    v_mfma_f32_16x16x32_bf16 a[92:95], a[212:215], v[108:111], a[92:95]
    buffer_load_dwordx4 v1, s[8:11], s19 offen offset:1024 sc1 lds
    s_waitcnt lgkmcnt(6)
    v_exp_f32 v133, v29
    v_mfma_f32_16x16x32_bf16 a[96:99], a[216:219], v[96:99], a[96:99]
    ds_read_b128 a[212:215], v1 offset:29696
    v_add_f32 v139, v132, v133
    v_mfma_f32_16x16x32_bf16 a[100:103], a[216:219], v[100:103], a[100:103]
    buffer_load_dwordx4 v1, s[8:11], s19 offen offset:2048 sc1 lds
    v_exp_f32 v134, v30
    v_mfma_f32_16x16x32_bf16 a[104:107], a[216:219], v[104:107], a[104:107]
    v_cvt_pk_bf16_f32 v92, v132, v133
    v_add_f32 v139, v139, v134
    v_mfma_f32_16x16x32_bf16 a[108:111], a[216:219], v[108:111], a[108:111]
    buffer_load_dwordx4 v1, s[8:11], s19 offen offset:3072 sc1 lds
    s_waitcnt lgkmcnt(6)
    v_exp_f32 v135, v31
    v_mfma_f32_16x16x32_bf16 a[112:115], a[220:223], v[96:99], a[112:115]
    s_add_u32 m0, s20, 69632
    ds_read_b128 a[216:219], v1 offset:30720
    v_add_f32 v139, v139, v135
    v_mfma_f32_16x16x32_bf16 a[116:119], a[220:223], v[100:103], a[116:119]
    buffer_load_dwordx4 v1, s[8:11], s21 offen offset:0 sc1 lds
    v_exp_f32 v128, v32
    v_mfma_f32_16x16x32_bf16 a[120:123], a[220:223], v[104:107], a[120:123]
    v_cvt_pk_bf16_f32 v93, v134, v135
    v_add_f32 v136, v136, v128
    v_mfma_f32_16x16x32_bf16 a[124:127], a[220:223], v[108:111], a[124:127]
    buffer_load_dwordx4 v1, s[8:11], s21 offen offset:1024 sc1 lds
    s_waitcnt lgkmcnt(6)
    v_exp_f32 v129, v33
    v_mfma_f32_16x16x32_bf16 v[48:51], a[192:195], a[128:131], v[112:115]
    ds_read_b128 a[220:223], v1 offset:31744
    v_add_f32 v136, v136, v129
    v_mfma_f32_16x16x32_bf16 v[52:55], a[192:195], a[144:147], v[116:119]
    buffer_load_dwordx4 v1, s[8:11], s21 offen offset:2048 sc1 lds
    v_exp_f32 v130, v34
    v_mfma_f32_16x16x32_bf16 v[56:59], a[192:195], a[160:163], v[120:123]
    v_cvt_pk_bf16_f32 v82, v128, v129
    v_add_f32 v136, v136, v130
    v_mfma_f32_16x16x32_bf16 v[60:63], a[192:195], a[176:179], v[124:127]
    buffer_load_dwordx4 v1, s[8:11], s21 offen offset:3072 sc1 lds
    s_waitcnt lgkmcnt(6)
    v_exp_f32 v131, v35
    v_mfma_f32_16x16x32_bf16 v[48:51], a[196:199], a[132:135], v[48:51]
    s_add_u32 s19, s23, s22
    s_add_u32 s21, s19, 4096
    s_add_u32 s22, s22, 16384
    s_and_b32 s22, s22, 0x7ffff
    s_add_u32 m0, s20, 98304
    ds_read_b128 a[192:195], v1 offset:32768
    v_add_f32 v136, v136, v131
    v_mfma_f32_16x16x32_bf16 v[52:55], a[196:199], a[148:151], v[52:55]
    buffer_load_dwordx4 v1, s[8:11], s19 offen offset:0 sc1 lds
    v_exp_f32 v132, v36
    v_mfma_f32_16x16x32_bf16 v[56:59], a[196:199], a[164:167], v[56:59]
    v_cvt_pk_bf16_f32 v83, v130, v131
    v_add_f32 v137, v137, v132
    v_mfma_f32_16x16x32_bf16 v[60:63], a[196:199], a[180:183], v[60:63]
    buffer_load_dwordx4 v1, s[8:11], s19 offen offset:1024 sc1 lds
    s_waitcnt lgkmcnt(6)
    v_exp_f32 v133, v37
    v_mfma_f32_16x16x32_bf16 v[48:51], a[200:203], a[136:139], v[48:51]
    ds_read_b128 a[196:199], v1 offset:33792
    v_add_f32 v137, v137, v133
    v_mfma_f32_16x16x32_bf16 v[52:55], a[200:203], a[152:155], v[52:55]
    buffer_load_dwordx4 v1, s[8:11], s19 offen offset:2048 sc1 lds
    v_exp_f32 v134, v38
    v_mfma_f32_16x16x32_bf16 v[56:59], a[200:203], a[168:171], v[56:59]
    v_cvt_pk_bf16_f32 v86, v132, v133
    v_add_f32 v137, v137, v134
    v_mfma_f32_16x16x32_bf16 v[60:63], a[200:203], a[184:187], v[60:63]
    buffer_load_dwordx4 v1, s[8:11], s19 offen offset:3072 sc1 lds
    s_waitcnt lgkmcnt(6)
    v_exp_f32 v135, v39
    v_mfma_f32_16x16x32_bf16 v[48:51], a[204:207], a[140:143], v[48:51]
    s_add_u32 m0, s20, 102400
    ds_read_b128 a[200:203], v1 offset:34816
    v_add_f32 v137, v137, v135
    v_mfma_f32_16x16x32_bf16 v[52:55], a[204:207], a[156:159], v[52:55]
    buffer_load_dwordx4 v1, s[8:11], s21 offen offset:0 sc1 lds
    v_exp_f32 v128, v40
    v_mfma_f32_16x16x32_bf16 v[56:59], a[204:207], a[172:175], v[56:59]
    v_cvt_pk_bf16_f32 v87, v134, v135
    v_add_f32 v138, v138, v128
    v_mfma_f32_16x16x32_bf16 v[60:63], a[204:207], a[188:191], v[60:63]
    buffer_load_dwordx4 v1, s[8:11], s21 offen offset:1024 sc1 lds
    s_waitcnt lgkmcnt(6)
    v_exp_f32 v129, v41
    v_mfma_f32_16x16x32_bf16 v[64:67], a[208:211], a[128:131], v[112:115]
    ds_read_b128 a[204:207], v1 offset:35840
    v_add_f32 v138, v138, v129
    v_mfma_f32_16x16x32_bf16 v[68:71], a[208:211], a[144:147], v[116:119]
    buffer_load_dwordx4 v1, s[8:11], s21 offen offset:2048 sc1 lds
    v_exp_f32 v130, v42
    v_mfma_f32_16x16x32_bf16 v[72:75], a[208:211], a[160:163], v[120:123]
    v_cvt_pk_bf16_f32 v90, v128, v129
    v_add_f32 v138, v138, v130
    v_mfma_f32_16x16x32_bf16 v[76:79], a[208:211], a[176:179], v[124:127]
    buffer_load_dwordx4 v1, s[8:11], s21 offen offset:3072 sc1 lds
    s_waitcnt lgkmcnt(6)
    v_exp_f32 v131, v43
    v_mfma_f32_16x16x32_bf16 v[64:67], a[212:215], a[132:135], v[64:67]
    ds_read_b128 a[208:211], v1 offset:36864
    v_add_f32 v138, v138, v131
    v_mfma_f32_16x16x32_bf16 v[68:71], a[212:215], a[148:151], v[68:71]
    v_exp_f32 v132, v44
    v_mfma_f32_16x16x32_bf16 v[72:75], a[212:215], a[164:167], v[72:75]
    v_cvt_pk_bf16_f32 v91, v130, v131
    v_add_f32 v139, v139, v132
    v_mfma_f32_16x16x32_bf16 v[76:79], a[212:215], a[180:183], v[76:79]
    s_waitcnt lgkmcnt(6)
    v_exp_f32 v133, v45
    v_mfma_f32_16x16x32_bf16 v[64:67], a[216:219], a[136:139], v[64:67]
    ds_read_b128 a[212:215], v1 offset:37888
    v_add_f32 v139, v139, v133
    v_mfma_f32_16x16x32_bf16 v[68:71], a[216:219], a[152:155], v[68:71]
    v_exp_f32 v134, v46
    v_max3_f32 v148, v136, v137, v138
    v_mfma_f32_16x16x32_bf16 v[72:75], a[216:219], a[168:171], v[72:75]
    v_cvt_pk_bf16_f32 v94, v132, v133
    v_add_f32 v139, v139, v134
    v_mfma_f32_16x16x32_bf16 v[76:79], a[216:219], a[184:187], v[76:79]
    s_waitcnt lgkmcnt(6)
    v_exp_f32 v135, v47
    v_mfma_f32_16x16x32_bf16 v[64:67], a[220:223], a[140:143], v[64:67]
    ds_read_b128 a[216:219], v1 offset:38912
    v_add_f32 v139, v139, v135
    v_mfma_f32_16x16x32_bf16 v[68:71], a[220:223], a[156:159], v[68:71]
    v_exp_f32 v128, v48
    v_max_f32 v148, v148, v139
    v_mfma_f32_16x16x32_bf16 v[72:75], a[220:223], a[172:175], v[72:75]
    v_cvt_pk_bf16_f32 v95, v134, v135
    v_cmp_lt_f32 vcc, s18, v148
    v_mfma_f32_16x16x32_bf16 v[76:79], a[220:223], a[188:191], v[76:79]
    s_waitcnt lgkmcnt(6)
    s_cbranch_vccnz L_tramp_1
L_back_1:
    v_exp_f32 v129, v49
    s_mov_b32 s17, 0
.p2align 6
L_loop:
    v_mfma_f32_16x16x32_bf16 a[0:3], a[192:195], v[80:83], a[0:3]
    ds_read_b128 a[220:223], v1 offset:39936
    v_add_f32 v140, v128, v129
    v_mfma_f32_16x16x32_bf16 a[4:7], a[192:195], v[84:87], a[4:7]
    v_exp_f32 v130, v50
    v_add_f32 v144, v144, v136
    v_mfma_f32_16x16x32_bf16 a[8:11], a[192:195], v[88:91], a[8:11]
    v_cvt_pk_bf16_f32 v96, v128, v129
    v_add_f32 v140, v140, v130
    v_mfma_f32_16x16x32_bf16 a[12:15], a[192:195], v[92:95], a[12:15]
    s_waitcnt lgkmcnt(6)
    v_exp_f32 v131, v51
    v_mfma_f32_16x16x32_bf16 a[16:19], a[196:199], v[80:83], a[16:19]
    ds_read_b128 a[192:195], v1 offset:40960
    v_add_f32 v140, v140, v131
    v_mfma_f32_16x16x32_bf16 a[20:23], a[196:199], v[84:87], a[20:23]
    v_exp_f32 v132, v52
    v_mfma_f32_16x16x32_bf16 a[24:27], a[196:199], v[88:91], a[24:27]
    v_cvt_pk_bf16_f32 v97, v130, v131
    v_add_f32 v145, v145, v137
    v_mfma_f32_16x16x32_bf16 a[28:31], a[196:199], v[92:95], a[28:31]
    s_waitcnt lgkmcnt(6)
    v_exp_f32 v133, v53
    v_mfma_f32_16x16x32_bf16 a[32:35], a[200:203], v[80:83], a[32:35]
    ds_read_b128 a[196:199], v1 offset:41984
    v_add_f32 v141, v132, v133
    v_mfma_f32_16x16x32_bf16 a[36:39], a[200:203], v[84:87], a[36:39]
    v_exp_f32 v134, v54
    v_mfma_f32_16x16x32_bf16 a[40:43], a[200:203], v[88:91], a[40:43]
    v_cvt_pk_bf16_f32 v100, v132, v133
    v_add_f32 v141, v141, v134
    v_mfma_f32_16x16x32_bf16 a[44:47], a[200:203], v[92:95], a[44:47]
    s_waitcnt lgkmcnt(6)
    v_exp_f32 v135, v55
    v_mfma_f32_16x16x32_bf16 a[48:51], a[204:207], v[80:83], a[48:51]
    ds_read_b128 a[200:203], v1 offset:43008
    v_add_f32 v141, v141, v135
    v_mfma_f32_16x16x32_bf16 a[52:55], a[204:207], v[84:87], a[52:55]
    v_exp_f32 v128, v56
    v_mfma_f32_16x16x32_bf16 a[56:59], a[204:207], v[88:91], a[56:59]
    v_cvt_pk_bf16_f32 v101, v134, v135
    v_add_f32 v146, v146, v138
    v_mfma_f32_16x16x32_bf16 a[60:63], a[204:207], v[92:95], a[60:63]
    s_waitcnt lgkmcnt(6)
    v_exp_f32 v129, v57
    v_mfma_f32_16x16x32_bf16 a[64:67], a[208:211], v[80:83], a[64:67]
    ds_read_b128 a[204:207], v1 offset:44032
    v_add_f32 v142, v128, v129
    v_mfma_f32_16x16x32_bf16 a[68:71], a[208:211], v[84:87], a[68:71]
    v_exp_f32 v130, v58
    v_mfma_f32_16x16x32_bf16 a[72:75], a[208:211], v[88:91], a[72:75]
    v_cvt_pk_bf16_f32 v104, v128, v129
    v_add_f32 v142, v142, v130
    v_mfma_f32_16x16x32_bf16 a[76:79], a[208:211], v[92:95], a[76:79]
    s_waitcnt lgkmcnt(6)
    v_exp_f32 v131, v59
    v_mfma_f32_16x16x32_bf16 a[80:83], a[212:215], v[80:83], a[80:83]
    ds_read_b128 a[208:211], v1 offset:45056
    v_add_f32 v142, v142, v131
    v_mfma_f32_16x16x32_bf16 a[84:87], a[212:215], v[84:87], a[84:87]
    v_exp_f32 v132, v60
    v_mfma_f32_16x16x32_bf16 a[88:91], a[212:215], v[88:91], a[88:91]
    v_cvt_pk_bf16_f32 v105, v130, v131
    v_add_f32 v147, v147, v139
    v_mfma_f32_16x16x32_bf16 a[92:95], a[212:215], v[92:95], a[92:95]
    s_waitcnt lgkmcnt(6)
    v_exp_f32 v133, v61
    v_mfma_f32_16x16x32_bf16 a[96:99], a[216:219], v[80:83], a[96:99]
    ds_read_b128 a[212:215], v1 offset:46080
    v_add_f32 v143, v132, v133
    v_mfma_f32_16x16x32_bf16 a[100:103], a[216:219], v[84:87], a[100:103]
    v_exp_f32 v134, v62
    v_mfma_f32_16x16x32_bf16 a[104:107], a[216:219], v[88:91], a[104:107]
    v_cvt_pk_bf16_f32 v108, v132, v133
    v_add_f32 v143, v143, v134
    v_mfma_f32_16x16x32_bf16 a[108:111], a[216:219], v[92:95], a[108:111]
    s_waitcnt lgkmcnt(6)
    v_exp_f32 v135, v63
    v_mfma_f32_16x16x32_bf16 a[112:115], a[220:223], v[80:83], a[112:115]
    ds_read_b128 a[216:219], v1 offset:47104
    v_add_f32 v143, v143, v135
    v_mfma_f32_16x16x32_bf16 a[116:119], a[220:223], v[84:87], a[116:119]
    v_exp_f32 v128, v64
    v_mfma_f32_16x16x32_bf16 a[120:123], a[220:223], v[88:91], a[120:123]
    v_cvt_pk_bf16_f32 v109, v134, v135
    v_add_f32 v140, v140, v128
    v_mfma_f32_16x16x32_bf16 a[124:127], a[220:223], v[92:95], a[124:127]
    s_waitcnt lgkmcnt(6)
    v_exp_f32 v129, v65
    v_mfma_f32_16x16x32_bf16 v[16:19], a[192:195], a[128:131], v[112:115]
    ds_read_b128 a[220:223], v1 offset:48128
    v_add_f32 v140, v140, v129
    v_mfma_f32_16x16x32_bf16 v[20:23], a[192:195], a[144:147], v[116:119]
    v_exp_f32 v130, v66
    v_mfma_f32_16x16x32_bf16 v[24:27], a[192:195], a[160:163], v[120:123]
    v_cvt_pk_bf16_f32 v98, v128, v129
    v_add_f32 v140, v140, v130
    v_mfma_f32_16x16x32_bf16 v[28:31], a[192:195], a[176:179], v[124:127]
    s_waitcnt lgkmcnt(6)
    v_exp_f32 v131, v67
    v_mfma_f32_16x16x32_bf16 v[16:19], a[196:199], a[132:135], v[16:19]
    ds_read_b128 a[192:195], v1 offset:49152
    v_add_f32 v140, v140, v131
    v_mfma_f32_16x16x32_bf16 v[20:23], a[196:199], a[148:151], v[20:23]
    v_exp_f32 v132, v68
    v_mfma_f32_16x16x32_bf16 v[24:27], a[196:199], a[164:167], v[24:27]
    v_cvt_pk_bf16_f32 v99, v130, v131
    v_add_f32 v141, v141, v132
    v_mfma_f32_16x16x32_bf16 v[28:31], a[196:199], a[180:183], v[28:31]
    s_waitcnt lgkmcnt(6)
    v_exp_f32 v133, v69
    v_mfma_f32_16x16x32_bf16 v[16:19], a[200:203], a[136:139], v[16:19]
    ds_read_b128 a[196:199], v1 offset:50176
    v_add_f32 v141, v141, v133
    v_mfma_f32_16x16x32_bf16 v[20:23], a[200:203], a[152:155], v[20:23]
    v_exp_f32 v134, v70
    v_mfma_f32_16x16x32_bf16 v[24:27], a[200:203], a[168:171], v[24:27]
    v_cvt_pk_bf16_f32 v102, v132, v133
    v_add_f32 v141, v141, v134
    v_mfma_f32_16x16x32_bf16 v[28:31], a[200:203], a[184:187], v[28:31]
    s_waitcnt lgkmcnt(6)
    v_exp_f32 v135, v71
    v_mfma_f32_16x16x32_bf16 v[16:19], a[204:207], a[140:143], v[16:19]
    ds_read_b128 a[200:203], v1 offset:51200
    v_add_f32 v141, v141, v135
    v_mfma_f32_16x16x32_bf16 v[20:23], a[204:207], a[156:159], v[20:23]
    v_exp_f32 v128, v72
    v_mfma_f32_16x16x32_bf16 v[24:27], a[204:207], a[172:175], v[24:27]
    v_cvt_pk_bf16_f32 v103, v134, v135
    v_add_f32 v142, v142, v128
    v_mfma_f32_16x16x32_bf16 v[28:31], a[204:207], a[188:191], v[28:31]
    s_waitcnt lgkmcnt(6)
    v_exp_f32 v129, v73
    v_mfma_f32_16x16x32_bf16 v[32:35], a[208:211], a[128:131], v[112:115]
    ds_read_b128 a[204:207], v1 offset:52224
    v_add_f32 v142, v142, v129
    v_mfma_f32_16x16x32_bf16 v[36:39], a[208:211], a[144:147], v[116:119]
    v_exp_f32 v130, v74
    v_mfma_f32_16x16x32_bf16 v[40:43], a[208:211], a[160:163], v[120:123]
    v_cvt_pk_bf16_f32 v106, v128, v129
    v_add_f32 v142, v142, v130
    v_mfma_f32_16x16x32_bf16 v[44:47], a[208:211], a[176:179], v[124:127]
    s_waitcnt lgkmcnt(6)
    v_exp_f32 v131, v75
    v_mfma_f32_16x16x32_bf16 v[32:35], a[212:215], a[132:135], v[32:35]
    ds_read_b128 a[208:211], v1 offset:53248
    v_add_f32 v142, v142, v131
    v_mfma_f32_16x16x32_bf16 v[36:39], a[212:215], a[148:151], v[36:39]
    v_exp_f32 v132, v76
    v_mfma_f32_16x16x32_bf16 v[40:43], a[212:215], a[164:167], v[40:43]
    v_cvt_pk_bf16_f32 v107, v130, v131
    v_add_f32 v143, v143, v132
    v_mfma_f32_16x16x32_bf16 v[44:47], a[212:215], a[180:183], v[44:47]
    s_waitcnt lgkmcnt(6)
    v_exp_f32 v133, v77
    v_mfma_f32_16x16x32_bf16 v[32:35], a[216:219], a[136:139], v[32:35]
    ds_read_b128 a[212:215], v1 offset:54272
    v_add_f32 v143, v143, v133
    v_mfma_f32_16x16x32_bf16 v[36:39], a[216:219], a[152:155], v[36:39]
    v_exp_f32 v134, v78
    v_max3_f32 v148, v140, v141, v142
    v_mfma_f32_16x16x32_bf16 v[40:43], a[216:219], a[168:171], v[40:43]
    v_cvt_pk_bf16_f32 v110, v132, v133
    v_add_f32 v143, v143, v134
    v_mfma_f32_16x16x32_bf16 v[44:47], a[216:219], a[184:187], v[44:47]
    s_waitcnt lgkmcnt(6)
    v_exp_f32 v135, v79
    v_mfma_f32_16x16x32_bf16 v[32:35], a[220:223], a[140:143], v[32:35]
    ds_read_b128 a[216:219], v1 offset:55296
    v_add_f32 v143, v143, v135
    v_mfma_f32_16x16x32_bf16 v[36:39], a[220:223], a[156:159], v[36:39]
    v_exp_f32 v128, v16
    v_max_f32 v148, v148, v143
    v_mfma_f32_16x16x32_bf16 v[40:43], a[220:223], a[172:175], v[40:43]
    v_cvt_pk_bf16_f32 v111, v134, v135
    v_cmp_lt_f32 vcc, s18, v148
    v_mfma_f32_16x16x32_bf16 v[44:47], a[220:223], a[188:191], v[44:47]
    s_waitcnt lgkmcnt(6)
    s_cbranch_vccnz L_tramp_2
L_back_2:
    v_exp_f32 v129, v17
    v_mfma_f32_16x16x32_bf16 a[0:3], a[192:195], v[96:99], a[0:3]
    ds_read_b128 a[220:223], v1 offset:56320
    v_add_f32 v136, v128, v129
    v_mfma_f32_16x16x32_bf16 a[4:7], a[192:195], v[100:103], a[4:7]
    v_exp_f32 v130, v18
    v_add_f32 v144, v144, v140
    v_mfma_f32_16x16x32_bf16 a[8:11], a[192:195], v[104:107], a[8:11]
    v_cvt_pk_bf16_f32 v80, v128, v129
    v_add_f32 v136, v136, v130
    v_mfma_f32_16x16x32_bf16 a[12:15], a[192:195], v[108:111], a[12:15]
    s_waitcnt lgkmcnt(6)
    v_exp_f32 v131, v19
    v_mfma_f32_16x16x32_bf16 a[16:19], a[196:199], v[96:99], a[16:19]
    ds_read_b128 a[192:195], v1 offset:57344
    v_add_f32 v136, v136, v131
    v_mfma_f32_16x16x32_bf16 a[20:23], a[196:199], v[100:103], a[20:23]
    v_exp_f32 v132, v20
    v_mfma_f32_16x16x32_bf16 a[24:27], a[196:199], v[104:107], a[24:27]
    v_cvt_pk_bf16_f32 v81, v130, v131
    v_add_f32 v145, v145, v141
    v_mfma_f32_16x16x32_bf16 a[28:31], a[196:199], v[108:111], a[28:31]
    s_waitcnt lgkmcnt(6)
    v_exp_f32 v133, v21
    v_mfma_f32_16x16x32_bf16 a[32:35], a[200:203], v[96:99], a[32:35]
    ds_read_b128 a[196:199], v1 offset:58368
    v_add_f32 v137, v132, v133
    v_mfma_f32_16x16x32_bf16 a[36:39], a[200:203], v[100:103], a[36:39]
    v_exp_f32 v134, v22
    v_mfma_f32_16x16x32_bf16 a[40:43], a[200:203], v[104:107], a[40:43]
    v_cvt_pk_bf16_f32 v84, v132, v133
    v_add_f32 v137, v137, v134
    v_mfma_f32_16x16x32_bf16 a[44:47], a[200:203], v[108:111], a[44:47]
    s_waitcnt lgkmcnt(6)
    v_exp_f32 v135, v23
    v_mfma_f32_16x16x32_bf16 a[48:51], a[204:207], v[96:99], a[48:51]
    ds_read_b128 a[200:203], v1 offset:59392
    v_add_f32 v137, v137, v135
    v_mfma_f32_16x16x32_bf16 a[52:55], a[204:207], v[100:103], a[52:55]
    v_exp_f32 v128, v24
    v_mfma_f32_16x16x32_bf16 a[56:59], a[204:207], v[104:107], a[56:59]
    v_cvt_pk_bf16_f32 v85, v134, v135
    v_add_f32 v146, v146, v142
    v_mfma_f32_16x16x32_bf16 a[60:63], a[204:207], v[108:111], a[60:63]
    s_waitcnt lgkmcnt(6)
    v_exp_f32 v129, v25
    v_mfma_f32_16x16x32_bf16 a[64:67], a[208:211], v[96:99], a[64:67]
    ds_read_b128 a[204:207], v1 offset:60416
    v_add_f32 v138, v128, v129
    v_mfma_f32_16x16x32_bf16 a[68:71], a[208:211], v[100:103], a[68:71]
    v_exp_f32 v130, v26
    v_mfma_f32_16x16x32_bf16 a[72:75], a[208:211], v[104:107], a[72:75]
    s_waitcnt vmcnt(8)
    s_barrier
    v_cvt_pk_bf16_f32 v88, v128, v129
    v_add_f32 v138, v138, v130
    v_mfma_f32_16x16x32_bf16 a[76:79], a[208:211], v[108:111], a[76:79]
    s_waitcnt lgkmcnt(6)
    v_exp_f32 v131, v27
    v_mfma_f32_16x16x32_bf16 a[80:83], a[212:215], v[96:99], a[80:83]
    s_add_u32 s19, s23, s22
    s_add_u32 s21, s19, 4096
    s_add_u32 s22, s22, 16384
    s_and_b32 s22, s22, 0x7ffff
    s_add_u32 m0, s20, 0
    ds_read_b128 a[208:211], v1 offset:61440
    v_add_f32 v138, v138, v131
    v_mfma_f32_16x16x32_bf16 a[84:87], a[212:215], v[100:103], a[84:87]
    buffer_load_dwordx4 v1, s[8:11], s19 offen offset:0 sc1 lds
    v_exp_f32 v132, v28
    v_mfma_f32_16x16x32_bf16 a[88:91], a[212:215], v[104:107], a[88:91]
    v_cvt_pk_bf16_f32 v89, v130, v131
    v_add_f32 v147, v147, v143
    v_mfma_f32_16x16x32_bf16 a[92:95], a[212:215], v[108:111], a[92:95]
    s_waitcnt lgkmcnt(6)
    v_exp_f32 v133, v29
    v_mfma_f32_16x16x32_bf16 a[96:99], a[216:219], v[96:99], a[96:99]
    ds_read_b128 a[212:215], v1 offset:62464
    v_add_f32 v139, v132, v133
    v_mfma_f32_16x16x32_bf16 a[100:103], a[216:219], v[100:103], a[100:103]
    buffer_load_dwordx4 v1, s[8:11], s19 offen offset:1024 sc1 lds
    v_exp_f32 v134, v30
    v_mfma_f32_16x16x32_bf16 a[104:107], a[216:219], v[104:107], a[104:107]
    v_cvt_pk_bf16_f32 v92, v132, v133
    v_add_f32 v139, v139, v134
    v_mfma_f32_16x16x32_bf16 a[108:111], a[216:219], v[108:111], a[108:111]
    s_waitcnt lgkmcnt(6)
    v_exp_f32 v135, v31
    v_mfma_f32_16x16x32_bf16 a[112:115], a[220:223], v[96:99], a[112:115]
    ds_read_b128 a[216:219], v1 offset:63488
    v_add_f32 v139, v139, v135
    v_mfma_f32_16x16x32_bf16 a[116:119], a[220:223], v[100:103], a[116:119]
    buffer_load_dwordx4 v1, s[8:11], s19 offen offset:2048 sc1 lds
    v_exp_f32 v128, v32
    v_mfma_f32_16x16x32_bf16 a[120:123], a[220:223], v[104:107], a[120:123]
    v_cvt_pk_bf16_f32 v93, v134, v135
    v_add_f32 v136, v136, v128
    v_mfma_f32_16x16x32_bf16 a[124:127], a[220:223], v[108:111], a[124:127]
    s_waitcnt lgkmcnt(6)
    v_exp_f32 v129, v33
    v_mfma_f32_16x16x32_bf16 v[48:51], a[192:195], a[128:131], v[112:115]
    ds_read_b128 a[220:223], v1 offset:64512
    v_add_f32 v136, v136, v129
    v_mfma_f32_16x16x32_bf16 v[52:55], a[192:195], a[144:147], v[116:119]
    buffer_load_dwordx4 v1, s[8:11], s19 offen offset:3072 sc1 lds
    v_exp_f32 v130, v34
    v_mfma_f32_16x16x32_bf16 v[56:59], a[192:195], a[160:163], v[120:123]
    v_cvt_pk_bf16_f32 v82, v128, v129
    v_add_f32 v136, v136, v130
    v_mfma_f32_16x16x32_bf16 v[60:63], a[192:195], a[176:179], v[124:127]
    s_waitcnt lgkmcnt(6)
    v_exp_f32 v131, v35
    v_mfma_f32_16x16x32_bf16 v[48:51], a[196:199], a[132:135], v[48:51]
    s_add_u32 m0, s20, 4096
    ds_read_b128 a[192:195], v2 offset:0
    v_add_f32 v136, v136, v131
    v_mfma_f32_16x16x32_bf16 v[52:55], a[196:199], a[148:151], v[52:55]
    buffer_load_dwordx4 v1, s[8:11], s21 offen offset:0 sc1 lds
    v_exp_f32 v132, v36
    v_mfma_f32_16x16x32_bf16 v[56:59], a[196:199], a[164:167], v[56:59]
    v_cvt_pk_bf16_f32 v83, v130, v131
    v_add_f32 v137, v137, v132
    v_mfma_f32_16x16x32_bf16 v[60:63], a[196:199], a[180:183], v[60:63]
    s_waitcnt lgkmcnt(6)
    v_exp_f32 v133, v37
    v_mfma_f32_16x16x32_bf16 v[48:51], a[200:203], a[136:139], v[48:51]
    ds_read_b128 a[196:199], v2 offset:1024
    v_add_f32 v137, v137, v133
    v_mfma_f32_16x16x32_bf16 v[52:55], a[200:203], a[152:155], v[52:55]
    buffer_load_dwordx4 v1, s[8:11], s21 offen offset:1024 sc1 lds
    v_exp_f32 v134, v38
    v_mfma_f32_16x16x32_bf16 v[56:59], a[200:203], a[168:171], v[56:59]
    v_cvt_pk_bf16_f32 v86, v132, v133
    v_add_f32 v137, v137, v134
    v_mfma_f32_16x16x32_bf16 v[60:63], a[200:203], a[184:187], v[60:63]
    s_waitcnt lgkmcnt(6)
    v_exp_f32 v135, v39
    v_mfma_f32_16x16x32_bf16 v[48:51], a[204:207], a[140:143], v[48:51]
    ds_read_b128 a[200:203], v2 offset:2048
    v_add_f32 v137, v137, v135
    v_mfma_f32_16x16x32_bf16 v[52:55], a[204:207], a[156:159], v[52:55]
    buffer_load_dwordx4 v1, s[8:11], s21 offen offset:2048 sc1 lds
    v_exp_f32 v128, v40
    v_mfma_f32_16x16x32_bf16 v[56:59], a[204:207], a[172:175], v[56:59]
    v_cvt_pk_bf16_f32 v87, v134, v135
    v_add_f32 v138, v138, v128
    v_mfma_f32_16x16x32_bf16 v[60:63], a[204:207], a[188:191], v[60:63]
    s_waitcnt lgkmcnt(6)
    v_exp_f32 v129, v41
    v_mfma_f32_16x16x32_bf16 v[64:67], a[208:211], a[128:131], v[112:115]
    ds_read_b128 a[204:207], v2 offset:3072
    v_add_f32 v138, v138, v129
    v_mfma_f32_16x16x32_bf16 v[68:71], a[208:211], a[144:147], v[116:119]
    buffer_load_dwordx4 v1, s[8:11], s21 offen offset:3072 sc1 lds
    v_exp_f32 v130, v42
    v_mfma_f32_16x16x32_bf16 v[72:75], a[208:211], a[160:163], v[120:123]
    v_cvt_pk_bf16_f32 v90, v128, v129
    v_add_f32 v138, v138, v130
    v_mfma_f32_16x16x32_bf16 v[76:79], a[208:211], a[176:179], v[124:127]
    s_waitcnt lgkmcnt(6)
    v_exp_f32 v131, v43
    v_mfma_f32_16x16x32_bf16 v[64:67], a[212:215], a[132:135], v[64:67]
    ds_read_b128 a[208:211], v2 offset:4096
    v_add_f32 v138, v138, v131
    v_mfma_f32_16x16x32_bf16 v[68:71], a[212:215], a[148:151], v[68:71]
    v_exp_f32 v132, v44
    v_mfma_f32_16x16x32_bf16 v[72:75], a[212:215], a[164:167], v[72:75]
    v_cvt_pk_bf16_f32 v91, v130, v131
    v_add_f32 v139, v139, v132
    v_mfma_f32_16x16x32_bf16 v[76:79], a[212:215], a[180:183], v[76:79]
    s_waitcnt lgkmcnt(6)
    v_exp_f32 v133, v45
    v_mfma_f32_16x16x32_bf16 v[64:67], a[216:219], a[136:139], v[64:67]
    ds_read_b128 a[212:215], v2 offset:5120
    v_add_f32 v139, v139, v133
    v_mfma_f32_16x16x32_bf16 v[68:71], a[216:219], a[152:155], v[68:71]
    v_exp_f32 v134, v46
    v_max3_f32 v148, v136, v137, v138
    v_mfma_f32_16x16x32_bf16 v[72:75], a[216:219], a[168:171], v[72:75]
    v_cvt_pk_bf16_f32 v94, v132, v133
    v_add_f32 v139, v139, v134
    v_mfma_f32_16x16x32_bf16 v[76:79], a[216:219], a[184:187], v[76:79]
    s_waitcnt lgkmcnt(6)
    v_exp_f32 v135, v47
    v_mfma_f32_16x16x32_bf16 v[64:67], a[220:223], a[140:143], v[64:67]
    ds_read_b128 a[216:219], v2 offset:6144
    v_add_f32 v139, v139, v135
    v_mfma_f32_16x16x32_bf16 v[68:71], a[220:223], a[156:159], v[68:71]
    v_exp_f32 v128, v48
    v_max_f32 v148, v148, v139
    v_mfma_f32_16x16x32_bf16 v[72:75], a[220:223], a[172:175], v[72:75]
    v_cvt_pk_bf16_f32 v95, v134, v135
    v_cmp_lt_f32 vcc, s18, v148
    v_mfma_f32_16x16x32_bf16 v[76:79], a[220:223], a[188:191], v[76:79]
    s_waitcnt lgkmcnt(6)
    s_cbranch_vccnz L_tramp_3
L_back_3:
    v_exp_f32 v129, v49
    v_mfma_f32_16x16x32_bf16 a[0:3], a[192:195], v[80:83], a[0:3]
    ds_read_b128 a[220:223], v2 offset:7168
    v_add_f32 v140, v128, v129
    v_mfma_f32_16x16x32_bf16 a[4:7], a[192:195], v[84:87], a[4:7]
    v_exp_f32 v130, v50
    v_add_f32 v144, v144, v136
    v_mfma_f32_16x16x32_bf16 a[8:11], a[192:195], v[88:91], a[8:11]
    v_cvt_pk_bf16_f32 v96, v128, v129
    v_add_f32 v140, v140, v130
    v_mfma_f32_16x16x32_bf16 a[12:15], a[192:195], v[92:95], a[12:15]
    s_waitcnt lgkmcnt(6)
    v_exp_f32 v131, v51
    v_mfma_f32_16x16x32_bf16 a[16:19], a[196:199], v[80:83], a[16:19]
    ds_read_b128 a[192:195], v2 offset:8192
    v_add_f32 v140, v140, v131
    v_mfma_f32_16x16x32_bf16 a[20:23], a[196:199], v[84:87], a[20:23]
    v_exp_f32 v132, v52
    v_mfma_f32_16x16x32_bf16 a[24:27], a[196:199], v[88:91], a[24:27]
    v_cvt_pk_bf16_f32 v97, v130, v131
    v_add_f32 v145, v145, v137
    v_mfma_f32_16x16x32_bf16 a[28:31], a[196:199], v[92:95], a[28:31]
    s_waitcnt lgkmcnt(6)
    v_exp_f32 v133, v53
    v_mfma_f32_16x16x32_bf16 a[32:35], a[200:203], v[80:83], a[32:35]
    ds_read_b128 a[196:199], v2 offset:9216
    v_add_f32 v141, v132, v133
    v_mfma_f32_16x16x32_bf16 a[36:39], a[200:203], v[84:87], a[36:39]
    v_exp_f32 v134, v54
    v_mfma_f32_16x16x32_bf16 a[40:43], a[200:203], v[88:91], a[40:43]
    v_cvt_pk_bf16_f32 v100, v132, v133
    v_add_f32 v141, v141, v134
    v_mfma_f32_16x16x32_bf16 a[44:47], a[200:203], v[92:95], a[44:47]
    s_waitcnt lgkmcnt(6)
    v_exp_f32 v135, v55
    v_mfma_f32_16x16x32_bf16 a[48:51], a[204:207], v[80:83], a[48:51]
    ds_read_b128 a[200:203], v2 offset:10240
    v_add_f32 v141, v141, v135
    v_mfma_f32_16x16x32_bf16 a[52:55], a[204:207], v[84:87], a[52:55]
    v_exp_f32 v128, v56
    v_mfma_f32_16x16x32_bf16 a[56:59], a[204:207], v[88:91], a[56:59]
    v_cvt_pk_bf16_f32 v101, v134, v135
    v_add_f32 v146, v146, v138
    v_mfma_f32_16x16x32_bf16 a[60:63], a[204:207], v[92:95], a[60:63]
    s_waitcnt lgkmcnt(6)
    v_exp_f32 v129, v57
    v_mfma_f32_16x16x32_bf16 a[64:67], a[208:211], v[80:83], a[64:67]
    ds_read_b128 a[204:207], v2 offset:11264
    v_add_f32 v142, v128, v129
    v_mfma_f32_16x16x32_bf16 a[68:71], a[208:211], v[84:87], a[68:71]
    v_exp_f32 v130, v58
    v_mfma_f32_16x16x32_bf16 a[72:75], a[208:211], v[88:91], a[72:75]
    v_cvt_pk_bf16_f32 v104, v128, v129
    v_add_f32 v142, v142, v130
    v_mfma_f32_16x16x32_bf16 a[76:79], a[208:211], v[92:95], a[76:79]
    s_waitcnt lgkmcnt(6)
    v_exp_f32 v131, v59
    v_mfma_f32_16x16x32_bf16 a[80:83], a[212:215], v[80:83], a[80:83]
    ds_read_b128 a[208:211], v2 offset:12288
    v_add_f32 v142, v142, v131
    v_mfma_f32_16x16x32_bf16 a[84:87], a[212:215], v[84:87], a[84:87]
    v_exp_f32 v132, v60
    v_mfma_f32_16x16x32_bf16 a[88:91], a[212:215], v[88:91], a[88:91]
    v_cvt_pk_bf16_f32 v105, v130, v131
    v_add_f32 v147, v147, v139
    v_mfma_f32_16x16x32_bf16 a[92:95], a[212:215], v[92:95], a[92:95]
    s_waitcnt lgkmcnt(6)
    v_exp_f32 v133, v61
    v_mfma_f32_16x16x32_bf16 a[96:99], a[216:219], v[80:83], a[96:99]
    ds_read_b128 a[212:215], v2 offset:13312
    v_add_f32 v143, v132, v133
    v_mfma_f32_16x16x32_bf16 a[100:103], a[216:219], v[84:87], a[100:103]
    v_exp_f32 v134, v62
    v_mfma_f32_16x16x32_bf16 a[104:107], a[216:219], v[88:91], a[104:107]
    v_cvt_pk_bf16_f32 v108, v132, v133
    v_add_f32 v143, v143, v134
    v_mfma_f32_16x16x32_bf16 a[108:111], a[216:219], v[92:95], a[108:111]
    s_waitcnt lgkmcnt(6)
    v_exp_f32 v135, v63
    v_mfma_f32_16x16x32_bf16 a[112:115], a[220:223], v[80:83], a[112:115]
    ds_read_b128 a[216:219], v2 offset:14336
    v_add_f32 v143, v143, v135
    v_mfma_f32_16x16x32_bf16 a[116:119], a[220:223], v[84:87], a[116:119]
    v_exp_f32 v128, v64
    v_mfma_f32_16x16x32_bf16 a[120:123], a[220:223], v[88:91], a[120:123]
    v_cvt_pk_bf16_f32 v109, v134, v135
    v_add_f32 v140, v140, v128
    v_mfma_f32_16x16x32_bf16 a[124:127], a[220:223], v[92:95], a[124:127]
    s_waitcnt lgkmcnt(6)
    v_exp_f32 v129, v65
    v_mfma_f32_16x16x32_bf16 v[16:19], a[192:195], a[128:131], v[112:115]
    ds_read_b128 a[220:223], v2 offset:15360
    v_add_f32 v140, v140, v129
    v_mfma_f32_16x16x32_bf16 v[20:23], a[192:195], a[144:147], v[116:119]
    v_exp_f32 v130, v66
    v_mfma_f32_16x16x32_bf16 v[24:27], a[192:195], a[160:163], v[120:123]
    v_cvt_pk_bf16_f32 v98, v128, v129
    v_add_f32 v140, v140, v130
    v_mfma_f32_16x16x32_bf16 v[28:31], a[192:195], a[176:179], v[124:127]
    s_waitcnt lgkmcnt(6)
    v_exp_f32 v131, v67
    v_mfma_f32_16x16x32_bf16 v[16:19], a[196:199], a[132:135], v[16:19]
    ds_read_b128 a[192:195], v2 offset:16384
    v_add_f32 v140, v140, v131
    v_mfma_f32_16x16x32_bf16 v[20:23], a[196:199], a[148:151], v[20:23]
    v_exp_f32 v132, v68
    v_mfma_f32_16x16x32_bf16 v[24:27], a[196:199], a[164:167], v[24:27]
    v_cvt_pk_bf16_f32 v99, v130, v131
    v_add_f32 v141, v141, v132
    v_mfma_f32_16x16x32_bf16 v[28:31], a[196:199], a[180:183], v[28:31]
    s_waitcnt lgkmcnt(6)
    v_exp_f32 v133, v69
    v_mfma_f32_16x16x32_bf16 v[16:19], a[200:203], a[136:139], v[16:19]
    ds_read_b128 a[196:199], v2 offset:17408
    v_add_f32 v141, v141, v133
    v_mfma_f32_16x16x32_bf16 v[20:23], a[200:203], a[152:155], v[20:23]
    v_exp_f32 v134, v70
    v_mfma_f32_16x16x32_bf16 v[24:27], a[200:203], a[168:171], v[24:27]
    v_cvt_pk_bf16_f32 v102, v132, v133
    v_add_f32 v141, v141, v134
    v_mfma_f32_16x16x32_bf16 v[28:31], a[200:203], a[184:187], v[28:31]
    s_waitcnt lgkmcnt(6)
    v_exp_f32 v135, v71
    v_mfma_f32_16x16x32_bf16 v[16:19], a[204:207], a[140:143], v[16:19]
    ds_read_b128 a[200:203], v2 offset:18432
    v_add_f32 v141, v141, v135
    v_mfma_f32_16x16x32_bf16 v[20:23], a[204:207], a[156:159], v[20:23]
    v_exp_f32 v128, v72
    v_mfma_f32_16x16x32_bf16 v[24:27], a[204:207], a[172:175], v[24:27]
    v_cvt_pk_bf16_f32 v103, v134, v135
    v_add_f32 v142, v142, v128
    v_mfma_f32_16x16x32_bf16 v[28:31], a[204:207], a[188:191], v[28:31]
    s_waitcnt lgkmcnt(6)
    v_exp_f32 v129, v73
    v_mfma_f32_16x16x32_bf16 v[32:35], a[208:211], a[128:131], v[112:115]
    ds_read_b128 a[204:207], v2 offset:19456
    v_add_f32 v142, v142, v129
    v_mfma_f32_16x16x32_bf16 v[36:39], a[208:211], a[144:147], v[116:119]
    v_exp_f32 v130, v74
    v_mfma_f32_16x16x32_bf16 v[40:43], a[208:211], a[160:163], v[120:123]
    v_cvt_pk_bf16_f32 v106, v128, v129
    v_add_f32 v142, v142, v130
    v_mfma_f32_16x16x32_bf16 v[44:47], a[208:211], a[176:179], v[124:127]
    s_waitcnt lgkmcnt(6)
    v_exp_f32 v131, v75
    v_mfma_f32_16x16x32_bf16 v[32:35], a[212:215], a[132:135], v[32:35]
    ds_read_b128 a[208:211], v2 offset:20480
    v_add_f32 v142, v142, v131
    v_mfma_f32_16x16x32_bf16 v[36:39], a[212:215], a[148:151], v[36:39]
    v_exp_f32 v132, v76
    v_mfma_f32_16x16x32_bf16 v[40:43], a[212:215], a[164:167], v[40:43]
    v_cvt_pk_bf16_f32 v107, v130, v131
    v_add_f32 v143, v143, v132
    v_mfma_f32_16x16x32_bf16 v[44:47], a[212:215], a[180:183], v[44:47]
    s_waitcnt lgkmcnt(6)
    v_exp_f32 v133, v77
    v_mfma_f32_16x16x32_bf16 v[32:35], a[216:219], a[136:139], v[32:35]
    ds_read_b128 a[212:215], v2 offset:21504
    v_add_f32 v143, v143, v133
    v_mfma_f32_16x16x32_bf16 v[36:39], a[216:219], a[152:155], v[36:39]
    v_exp_f32 v134, v78
    v_max3_f32 v148, v140, v141, v142
    v_mfma_f32_16x16x32_bf16 v[40:43], a[216:219], a[168:171], v[40:43]
    v_cvt_pk_bf16_f32 v110, v132, v133
    v_add_f32 v143, v143, v134
    v_mfma_f32_16x16x32_bf16 v[44:47], a[216:219], a[184:187], v[44:47]
    s_waitcnt lgkmcnt(6)
    v_exp_f32 v135, v79
    v_mfma_f32_16x16x32_bf16 v[32:35], a[220:223], a[140:143], v[32:35]
    ds_read_b128 a[216:219], v2 offset:22528
    v_add_f32 v143, v143, v135
    v_mfma_f32_16x16x32_bf16 v[36:39], a[220:223], a[156:159], v[36:39]
    v_exp_f32 v128, v16
    v_max_f32 v148, v148, v143
    v_mfma_f32_16x16x32_bf16 v[40:43], a[220:223], a[172:175], v[40:43]
    v_cvt_pk_bf16_f32 v111, v134, v135
    v_cmp_lt_f32 vcc, s18, v148
    v_mfma_f32_16x16x32_bf16 v[44:47], a[220:223], a[188:191], v[44:47]
    s_waitcnt lgkmcnt(6)
    s_cbranch_vccnz L_tramp_4
L_back_4:
    v_exp_f32 v129, v17
    v_mfma_f32_16x16x32_bf16 a[0:3], a[192:195], v[96:99], a[0:3]
    ds_read_b128 a[220:223], v2 offset:23552
    v_add_f32 v136, v128, v129
    v_mfma_f32_16x16x32_bf16 a[4:7], a[192:195], v[100:103], a[4:7]
    v_exp_f32 v130, v18
    v_add_f32 v144, v144, v140
    v_mfma_f32_16x16x32_bf16 a[8:11], a[192:195], v[104:107], a[8:11]
    v_cvt_pk_bf16_f32 v80, v128, v129
    v_add_f32 v136, v136, v130
    v_mfma_f32_16x16x32_bf16 a[12:15], a[192:195], v[108:111], a[12:15]
    s_waitcnt lgkmcnt(6)
    v_exp_f32 v131, v19
    v_mfma_f32_16x16x32_bf16 a[16:19], a[196:199], v[96:99], a[16:19]
    ds_read_b128 a[192:195], v2 offset:24576
    v_add_f32 v136, v136, v131
    v_mfma_f32_16x16x32_bf16 a[20:23], a[196:199], v[100:103], a[20:23]
    v_exp_f32 v132, v20
    v_mfma_f32_16x16x32_bf16 a[24:27], a[196:199], v[104:107], a[24:27]
    v_cvt_pk_bf16_f32 v81, v130, v131
    v_add_f32 v145, v145, v141
    v_mfma_f32_16x16x32_bf16 a[28:31], a[196:199], v[108:111], a[28:31]
    s_waitcnt lgkmcnt(6)
    v_exp_f32 v133, v21
    v_mfma_f32_16x16x32_bf16 a[32:35], a[200:203], v[96:99], a[32:35]
    ds_read_b128 a[196:199], v2 offset:25600
    v_add_f32 v137, v132, v133
    v_mfma_f32_16x16x32_bf16 a[36:39], a[200:203], v[100:103], a[36:39]
    v_exp_f32 v134, v22
    v_mfma_f32_16x16x32_bf16 a[40:43], a[200:203], v[104:107], a[40:43]
    v_cvt_pk_bf16_f32 v84, v132, v133
    v_add_f32 v137, v137, v134
    v_mfma_f32_16x16x32_bf16 a[44:47], a[200:203], v[108:111], a[44:47]
    s_waitcnt lgkmcnt(6)
    v_exp_f32 v135, v23
    v_mfma_f32_16x16x32_bf16 a[48:51], a[204:207], v[96:99], a[48:51]
    ds_read_b128 a[200:203], v2 offset:26624
    v_add_f32 v137, v137, v135
    v_mfma_f32_16x16x32_bf16 a[52:55], a[204:207], v[100:103], a[52:55]
    v_exp_f32 v128, v24
    v_mfma_f32_16x16x32_bf16 a[56:59], a[204:207], v[104:107], a[56:59]
    v_cvt_pk_bf16_f32 v85, v134, v135
    v_add_f32 v146, v146, v142
    v_mfma_f32_16x16x32_bf16 a[60:63], a[204:207], v[108:111], a[60:63]
    s_waitcnt lgkmcnt(6)
    v_exp_f32 v129, v25
    v_mfma_f32_16x16x32_bf16 a[64:67], a[208:211], v[96:99], a[64:67]
    ds_read_b128 a[204:207], v2 offset:27648
    v_add_f32 v138, v128, v129
    v_mfma_f32_16x16x32_bf16 a[68:71], a[208:211], v[100:103], a[68:71]
    v_exp_f32 v130, v26
    v_mfma_f32_16x16x32_bf16 a[72:75], a[208:211], v[104:107], a[72:75]
    s_waitcnt vmcnt(8)
    s_barrier
    v_cvt_pk_bf16_f32 v88, v128, v129
    v_add_f32 v138, v138, v130
    v_mfma_f32_16x16x32_bf16 a[76:79], a[208:211], v[108:111], a[76:79]
    s_waitcnt lgkmcnt(6)
    v_exp_f32 v131, v27
    v_mfma_f32_16x16x32_bf16 a[80:83], a[212:215], v[96:99], a[80:83]
    s_add_u32 s19, s23, s22
    s_add_u32 s21, s19, 4096
    s_add_u32 s22, s22, 16384
    s_and_b32 s22, s22, 0x7ffff
    s_add_u32 m0, s20, 32768
    ds_read_b128 a[208:211], v2 offset:28672
    v_add_f32 v138, v138, v131
    v_mfma_f32_16x16x32_bf16 a[84:87], a[212:215], v[100:103], a[84:87]
    buffer_load_dwordx4 v1, s[8:11], s19 offen offset:0 sc1 lds
    v_exp_f32 v132, v28
    v_mfma_f32_16x16x32_bf16 a[88:91], a[212:215], v[104:107], a[88:91]
    v_cvt_pk_bf16_f32 v89, v130, v131
    v_add_f32 v147, v147, v143
    v_mfma_f32_16x16x32_bf16 a[92:95], a[212:215], v[108:111], a[92:95]
    s_waitcnt lgkmcnt(6)
    v_exp_f32 v133, v29
    v_mfma_f32_16x16x32_bf16 a[96:99], a[216:219], v[96:99], a[96:99]
    ds_read_b128 a[212:215], v2 offset:29696
    v_add_f32 v139, v132, v133
    v_mfma_f32_16x16x32_bf16 a[100:103], a[216:219], v[100:103], a[100:103]
    buffer_load_dwordx4 v1, s[8:11], s19 offen offset:1024 sc1 lds
    v_exp_f32 v134, v30
    v_mfma_f32_16x16x32_bf16 a[104:107], a[216:219], v[104:107], a[104:107]
    v_cvt_pk_bf16_f32 v92, v132, v133
    v_add_f32 v139, v139, v134
    v_mfma_f32_16x16x32_bf16 a[108:111], a[216:219], v[108:111], a[108:111]
    s_waitcnt lgkmcnt(6)
    v_exp_f32 v135, v31
    v_mfma_f32_16x16x32_bf16 a[112:115], a[220:223], v[96:99], a[112:115]
    ds_read_b128 a[216:219], v2 offset:30720
    v_add_f32 v139, v139, v135
    v_mfma_f32_16x16x32_bf16 a[116:119], a[220:223], v[100:103], a[116:119]
    buffer_load_dwordx4 v1, s[8:11], s19 offen offset:2048 sc1 lds
    v_exp_f32 v128, v32
    v_mfma_f32_16x16x32_bf16 a[120:123], a[220:223], v[104:107], a[120:123]
    v_cvt_pk_bf16_f32 v93, v134, v135
    v_add_f32 v136, v136, v128
    v_mfma_f32_16x16x32_bf16 a[124:127], a[220:223], v[108:111], a[124:127]
    s_waitcnt lgkmcnt(6)
    v_exp_f32 v129, v33
    v_mfma_f32_16x16x32_bf16 v[48:51], a[192:195], a[128:131], v[112:115]
    ds_read_b128 a[220:223], v2 offset:31744
    v_add_f32 v136, v136, v129
    v_mfma_f32_16x16x32_bf16 v[52:55], a[192:195], a[144:147], v[116:119]
    buffer_load_dwordx4 v1, s[8:11], s19 offen offset:3072 sc1 lds
    v_exp_f32 v130, v34
    v_mfma_f32_16x16x32_bf16 v[56:59], a[192:195], a[160:163], v[120:123]
    v_cvt_pk_bf16_f32 v82, v128, v129
    v_add_f32 v136, v136, v130
    v_mfma_f32_16x16x32_bf16 v[60:63], a[192:195], a[176:179], v[124:127]
    s_waitcnt lgkmcnt(6)
    v_exp_f32 v131, v35
    v_mfma_f32_16x16x32_bf16 v[48:51], a[196:199], a[132:135], v[48:51]
    s_add_u32 m0, s20, 36864
    ds_read_b128 a[192:195], v2 offset:32768
    v_add_f32 v136, v136, v131
    v_mfma_f32_16x16x32_bf16 v[52:55], a[196:199], a[148:151], v[52:55]
    buffer_load_dwordx4 v1, s[8:11], s21 offen offset:0 sc1 lds
    v_exp_f32 v132, v36
    v_mfma_f32_16x16x32_bf16 v[56:59], a[196:199], a[164:167], v[56:59]
    v_cvt_pk_bf16_f32 v83, v130, v131
    v_add_f32 v137, v137, v132
    v_mfma_f32_16x16x32_bf16 v[60:63], a[196:199], a[180:183], v[60:63]
    s_waitcnt lgkmcnt(6)
    v_exp_f32 v133, v37
    v_mfma_f32_16x16x32_bf16 v[48:51], a[200:203], a[136:139], v[48:51]
    ds_read_b128 a[196:199], v2 offset:33792
    v_add_f32 v137, v137, v133
    v_mfma_f32_16x16x32_bf16 v[52:55], a[200:203], a[152:155], v[52:55]
    buffer_load_dwordx4 v1, s[8:11], s21 offen offset:1024 sc1 lds
    v_exp_f32 v134, v38
    v_mfma_f32_16x16x32_bf16 v[56:59], a[200:203], a[168:171], v[56:59]
    v_cvt_pk_bf16_f32 v86, v132, v133
    v_add_f32 v137, v137, v134
    v_mfma_f32_16x16x32_bf16 v[60:63], a[200:203], a[184:187], v[60:63]
    s_waitcnt lgkmcnt(6)
    v_exp_f32 v135, v39
    v_mfma_f32_16x16x32_bf16 v[48:51], a[204:207], a[140:143], v[48:51]
    ds_read_b128 a[200:203], v2 offset:34816
    v_add_f32 v137, v137, v135
    v_mfma_f32_16x16x32_bf16 v[52:55], a[204:207], a[156:159], v[52:55]
    buffer_load_dwordx4 v1, s[8:11], s21 offen offset:2048 sc1 lds
    v_exp_f32 v128, v40
    v_mfma_f32_16x16x32_bf16 v[56:59], a[204:207], a[172:175], v[56:59]
    v_cvt_pk_bf16_f32 v87, v134, v135
    v_add_f32 v138, v138, v128
    v_mfma_f32_16x16x32_bf16 v[60:63], a[204:207], a[188:191], v[60:63]
    s_waitcnt lgkmcnt(6)
    v_exp_f32 v129, v41
    v_mfma_f32_16x16x32_bf16 v[64:67], a[208:211], a[128:131], v[112:115]
    ds_read_b128 a[204:207], v2 offset:35840
    v_add_f32 v138, v138, v129
    v_mfma_f32_16x16x32_bf16 v[68:71], a[208:211], a[144:147], v[116:119]
    buffer_load_dwordx4 v1, s[8:11], s21 offen offset:3072 sc1 lds
    v_exp_f32 v130, v42
    v_mfma_f32_16x16x32_bf16 v[72:75], a[208:211], a[160:163], v[120:123]
    v_cvt_pk_bf16_f32 v90, v128, v129
    v_add_f32 v138, v138, v130
    v_mfma_f32_16x16x32_bf16 v[76:79], a[208:211], a[176:179], v[124:127]
    s_waitcnt lgkmcnt(6)
    v_exp_f32 v131, v43
    v_mfma_f32_16x16x32_bf16 v[64:67], a[212:215], a[132:135], v[64:67]
    ds_read_b128 a[208:211], v2 offset:36864
    v_add_f32 v138, v138, v131
    v_mfma_f32_16x16x32_bf16 v[68:71], a[212:215], a[148:151], v[68:71]
    v_exp_f32 v132, v44
    v_mfma_f32_16x16x32_bf16 v[72:75], a[212:215], a[164:167], v[72:75]
    v_cvt_pk_bf16_f32 v91, v130, v131
    v_add_f32 v139, v139, v132
    v_mfma_f32_16x16x32_bf16 v[76:79], a[212:215], a[180:183], v[76:79]
    s_waitcnt lgkmcnt(6)
    v_exp_f32 v133, v45
    v_mfma_f32_16x16x32_bf16 v[64:67], a[216:219], a[136:139], v[64:67]
    ds_read_b128 a[212:215], v2 offset:37888
    v_add_f32 v139, v139, v133
    v_mfma_f32_16x16x32_bf16 v[68:71], a[216:219], a[152:155], v[68:71]
    v_exp_f32 v134, v46
    v_max3_f32 v148, v136, v137, v138
    v_mfma_f32_16x16x32_bf16 v[72:75], a[216:219], a[168:171], v[72:75]
    v_cvt_pk_bf16_f32 v94, v132, v133
    v_add_f32 v139, v139, v134
    v_mfma_f32_16x16x32_bf16 v[76:79], a[216:219], a[184:187], v[76:79]
    s_waitcnt lgkmcnt(6)
    v_exp_f32 v135, v47
    v_mfma_f32_16x16x32_bf16 v[64:67], a[220:223], a[140:143], v[64:67]
    ds_read_b128 a[216:219], v2 offset:38912
    v_add_f32 v139, v139, v135
    v_mfma_f32_16x16x32_bf16 v[68:71], a[220:223], a[156:159], v[68:71]
    v_exp_f32 v128, v48
    v_max_f32 v148, v148, v139
    v_mfma_f32_16x16x32_bf16 v[72:75], a[220:223], a[172:175], v[72:75]
    v_cvt_pk_bf16_f32 v95, v134, v135
    v_cmp_lt_f32 vcc, s18, v148
    v_mfma_f32_16x16x32_bf16 v[76:79], a[220:223], a[188:191], v[76:79]
    s_waitcnt lgkmcnt(6)
    s_cbranch_vccnz L_tramp_5
L_back_5:
    v_exp_f32 v129, v49
    v_mfma_f32_16x16x32_bf16 a[0:3], a[192:195], v[80:83], a[0:3]
    ds_read_b128 a[220:223], v2 offset:39936
    v_add_f32 v140, v128, v129
    v_mfma_f32_16x16x32_bf16 a[4:7], a[192:195], v[84:87], a[4:7]
    v_exp_f32 v130, v50
    v_add_f32 v144, v144, v136
    v_mfma_f32_16x16x32_bf16 a[8:11], a[192:195], v[88:91], a[8:11]
    v_cvt_pk_bf16_f32 v96, v128, v129
    v_add_f32 v140, v140, v130
    v_mfma_f32_16x16x32_bf16 a[12:15], a[192:195], v[92:95], a[12:15]
    s_waitcnt lgkmcnt(6)
    v_exp_f32 v131, v51
    v_mfma_f32_16x16x32_bf16 a[16:19], a[196:199], v[80:83], a[16:19]
    ds_read_b128 a[192:195], v2 offset:40960
    v_add_f32 v140, v140, v131
    v_mfma_f32_16x16x32_bf16 a[20:23], a[196:199], v[84:87], a[20:23]
    v_exp_f32 v132, v52
    v_mfma_f32_16x16x32_bf16 a[24:27], a[196:199], v[88:91], a[24:27]
    v_cvt_pk_bf16_f32 v97, v130, v131
    v_add_f32 v145, v145, v137
    v_mfma_f32_16x16x32_bf16 a[28:31], a[196:199], v[92:95], a[28:31]
    s_waitcnt lgkmcnt(6)
    v_exp_f32 v133, v53
    v_mfma_f32_16x16x32_bf16 a[32:35], a[200:203], v[80:83], a[32:35]
    ds_read_b128 a[196:199], v2 offset:41984
    v_add_f32 v141, v132, v133
    v_mfma_f32_16x16x32_bf16 a[36:39], a[200:203], v[84:87], a[36:39]
    v_exp_f32 v134, v54
    v_mfma_f32_16x16x32_bf16 a[40:43], a[200:203], v[88:91], a[40:43]
    v_cvt_pk_bf16_f32 v100, v132, v133
    v_add_f32 v141, v141, v134
    v_mfma_f32_16x16x32_bf16 a[44:47], a[200:203], v[92:95], a[44:47]
    s_waitcnt lgkmcnt(6)
    v_exp_f32 v135, v55
    v_mfma_f32_16x16x32_bf16 a[48:51], a[204:207], v[80:83], a[48:51]
    ds_read_b128 a[200:203], v2 offset:43008
    v_add_f32 v141, v141, v135
    v_mfma_f32_16x16x32_bf16 a[52:55], a[204:207], v[84:87], a[52:55]
    v_exp_f32 v128, v56
    v_mfma_f32_16x16x32_bf16 a[56:59], a[204:207], v[88:91], a[56:59]
    v_cvt_pk_bf16_f32 v101, v134, v135
    v_add_f32 v146, v146, v138
    v_mfma_f32_16x16x32_bf16 a[60:63], a[204:207], v[92:95], a[60:63]
    s_waitcnt lgkmcnt(6)
    v_exp_f32 v129, v57
    v_mfma_f32_16x16x32_bf16 a[64:67], a[208:211], v[80:83], a[64:67]
    ds_read_b128 a[204:207], v2 offset:44032
    v_add_f32 v142, v128, v129
    v_mfma_f32_16x16x32_bf16 a[68:71], a[208:211], v[84:87], a[68:71]
    v_exp_f32 v130, v58
    v_mfma_f32_16x16x32_bf16 a[72:75], a[208:211], v[88:91], a[72:75]
    v_cvt_pk_bf16_f32 v104, v128, v129
    v_add_f32 v142, v142, v130
    v_mfma_f32_16x16x32_bf16 a[76:79], a[208:211], v[92:95], a[76:79]
    s_waitcnt lgkmcnt(6)
    v_exp_f32 v131, v59
    v_mfma_f32_16x16x32_bf16 a[80:83], a[212:215], v[80:83], a[80:83]
    ds_read_b128 a[208:211], v2 offset:45056
    v_add_f32 v142, v142, v131
    v_mfma_f32_16x16x32_bf16 a[84:87], a[212:215], v[84:87], a[84:87]
    v_exp_f32 v132, v60
    v_mfma_f32_16x16x32_bf16 a[88:91], a[212:215], v[88:91], a[88:91]
    v_cvt_pk_bf16_f32 v105, v130, v131
    v_add_f32 v147, v147, v139
    v_mfma_f32_16x16x32_bf16 a[92:95], a[212:215], v[92:95], a[92:95]
    s_waitcnt lgkmcnt(6)
    v_exp_f32 v133, v61
    v_mfma_f32_16x16x32_bf16 a[96:99], a[216:219], v[80:83], a[96:99]
    ds_read_b128 a[212:215], v2 offset:46080
    v_add_f32 v143, v132, v133
    v_mfma_f32_16x16x32_bf16 a[100:103], a[216:219], v[84:87], a[100:103]
    v_exp_f32 v134, v62
    v_mfma_f32_16x16x32_bf16 a[104:107], a[216:219], v[88:91], a[104:107]
    v_cvt_pk_bf16_f32 v108, v132, v133
    v_add_f32 v143, v143, v134
    v_mfma_f32_16x16x32_bf16 a[108:111], a[216:219], v[92:95], a[108:111]
    s_waitcnt lgkmcnt(6)
    v_exp_f32 v135, v63
    v_mfma_f32_16x16x32_bf16 a[112:115], a[220:223], v[80:83], a[112:115]
    ds_read_b128 a[216:219], v2 offset:47104
    v_add_f32 v143, v143, v135
    v_mfma_f32_16x16x32_bf16 a[116:119], a[220:223], v[84:87], a[116:119]
    v_exp_f32 v128, v64
    v_mfma_f32_16x16x32_bf16 a[120:123], a[220:223], v[88:91], a[120:123]
    v_cvt_pk_bf16_f32 v109, v134, v135
    v_add_f32 v140, v140, v128
    v_mfma_f32_16x16x32_bf16 a[124:127], a[220:223], v[92:95], a[124:127]
    s_waitcnt lgkmcnt(6)
    v_exp_f32 v129, v65
    v_mfma_f32_16x16x32_bf16 v[16:19], a[192:195], a[128:131], v[112:115]
    ds_read_b128 a[220:223], v2 offset:48128
    v_add_f32 v140, v140, v129
    v_mfma_f32_16x16x32_bf16 v[20:23], a[192:195], a[144:147], v[116:119]
    v_exp_f32 v130, v66
    v_mfma_f32_16x16x32_bf16 v[24:27], a[192:195], a[160:163], v[120:123]
    v_cvt_pk_bf16_f32 v98, v128, v129
    v_add_f32 v140, v140, v130
    v_mfma_f32_16x16x32_bf16 v[28:31], a[192:195], a[176:179], v[124:127]
    s_waitcnt lgkmcnt(6)
    v_exp_f32 v131, v67
    v_mfma_f32_16x16x32_bf16 v[16:19], a[196:199], a[132:135], v[16:19]
    ds_read_b128 a[192:195], v2 offset:49152
    v_add_f32 v140, v140, v131
    v_mfma_f32_16x16x32_bf16 v[20:23], a[196:199], a[148:151], v[20:23]
    v_exp_f32 v132, v68
    v_mfma_f32_16x16x32_bf16 v[24:27], a[196:199], a[164:167], v[24:27]
    v_cvt_pk_bf16_f32 v99, v130, v131
    v_add_f32 v141, v141, v132
    v_mfma_f32_16x16x32_bf16 v[28:31], a[196:199], a[180:183], v[28:31]
    s_waitcnt lgkmcnt(6)
    v_exp_f32 v133, v69
    v_mfma_f32_16x16x32_bf16 v[16:19], a[200:203], a[136:139], v[16:19]
    ds_read_b128 a[196:199], v2 offset:50176
    v_add_f32 v141, v141, v133
    v_mfma_f32_16x16x32_bf16 v[20:23], a[200:203], a[152:155], v[20:23]
    v_exp_f32 v134, v70
    v_mfma_f32_16x16x32_bf16 v[24:27], a[200:203], a[168:171], v[24:27]
    v_cvt_pk_bf16_f32 v102, v132, v133
    v_add_f32 v141, v141, v134
    v_mfma_f32_16x16x32_bf16 v[28:31], a[200:203], a[184:187], v[28:31]
    s_waitcnt lgkmcnt(6)
    v_exp_f32 v135, v71
    v_mfma_f32_16x16x32_bf16 v[16:19], a[204:207], a[140:143], v[16:19]
    ds_read_b128 a[200:203], v2 offset:51200
    v_add_f32 v141, v141, v135
    v_mfma_f32_16x16x32_bf16 v[20:23], a[204:207], a[156:159], v[20:23]
    v_exp_f32 v128, v72
    v_mfma_f32_16x16x32_bf16 v[24:27], a[204:207], a[172:175], v[24:27]
    v_cvt_pk_bf16_f32 v103, v134, v135
    v_add_f32 v142, v142, v128
    v_mfma_f32_16x16x32_bf16 v[28:31], a[204:207], a[188:191], v[28:31]
    s_waitcnt lgkmcnt(6)
    v_exp_f32 v129, v73
    v_mfma_f32_16x16x32_bf16 v[32:35], a[208:211], a[128:131], v[112:115]
    ds_read_b128 a[204:207], v2 offset:52224
    v_add_f32 v142, v142, v129
    v_mfma_f32_16x16x32_bf16 v[36:39], a[208:211], a[144:147], v[116:119]
    v_exp_f32 v130, v74
    v_mfma_f32_16x16x32_bf16 v[40:43], a[208:211], a[160:163], v[120:123]
    v_cvt_pk_bf16_f32 v106, v128, v129
    v_add_f32 v142, v142, v130
    v_mfma_f32_16x16x32_bf16 v[44:47], a[208:211], a[176:179], v[124:127]
    s_waitcnt lgkmcnt(6)
    v_exp_f32 v131, v75
    v_mfma_f32_16x16x32_bf16 v[32:35], a[212:215], a[132:135], v[32:35]
    ds_read_b128 a[208:211], v2 offset:53248
    v_add_f32 v142, v142, v131
    v_mfma_f32_16x16x32_bf16 v[36:39], a[212:215], a[148:151], v[36:39]
    v_exp_f32 v132, v76
    v_mfma_f32_16x16x32_bf16 v[40:43], a[212:215], a[164:167], v[40:43]
    v_cvt_pk_bf16_f32 v107, v130, v131
    v_add_f32 v143, v143, v132
    v_mfma_f32_16x16x32_bf16 v[44:47], a[212:215], a[180:183], v[44:47]
    s_waitcnt lgkmcnt(6)
    v_exp_f32 v133, v77
    v_mfma_f32_16x16x32_bf16 v[32:35], a[216:219], a[136:139], v[32:35]
    ds_read_b128 a[212:215], v2 offset:54272
    v_add_f32 v143, v143, v133
    v_mfma_f32_16x16x32_bf16 v[36:39], a[216:219], a[152:155], v[36:39]
    v_exp_f32 v134, v78
    v_max3_f32 v148, v140, v141, v142
    v_mfma_f32_16x16x32_bf16 v[40:43], a[216:219], a[168:171], v[40:43]
    v_cvt_pk_bf16_f32 v110, v132, v133
    v_add_f32 v143, v143, v134
    v_mfma_f32_16x16x32_bf16 v[44:47], a[216:219], a[184:187], v[44:47]
    s_waitcnt lgkmcnt(6)
    v_exp_f32 v135, v79
    v_mfma_f32_16x16x32_bf16 v[32:35], a[220:223], a[140:143], v[32:35]
    ds_read_b128 a[216:219], v2 offset:55296
    v_add_f32 v143, v143, v135
    v_mfma_f32_16x16x32_bf16 v[36:39], a[220:223], a[156:159], v[36:39]
    v_exp_f32 v128, v16
    v_max_f32 v148, v148, v143
    v_mfma_f32_16x16x32_bf16 v[40:43], a[220:223], a[172:175], v[40:43]
    v_cvt_pk_bf16_f32 v111, v134, v135
    v_cmp_lt_f32 vcc, s18, v148
    v_mfma_f32_16x16x32_bf16 v[44:47], a[220:223], a[188:191], v[44:47]
    s_waitcnt lgkmcnt(6)
    s_cbranch_vccnz L_tramp_6
L_back_6:
    v_exp_f32 v129, v17
    v_mfma_f32_16x16x32_bf16 a[0:3], a[192:195], v[96:99], a[0:3]
    ds_read_b128 a[220:223], v2 offset:56320
    v_add_f32 v136, v128, v129
    v_mfma_f32_16x16x32_bf16 a[4:7], a[192:195], v[100:103], a[4:7]
    v_exp_f32 v130, v18
    v_add_f32 v144, v144, v140
    v_mfma_f32_16x16x32_bf16 a[8:11], a[192:195], v[104:107], a[8:11]
    v_cvt_pk_bf16_f32 v80, v128, v129
    v_add_f32 v136, v136, v130
    v_mfma_f32_16x16x32_bf16 a[12:15], a[192:195], v[108:111], a[12:15]
    s_waitcnt lgkmcnt(6)
    v_exp_f32 v131, v19
    v_mfma_f32_16x16x32_bf16 a[16:19], a[196:199], v[96:99], a[16:19]
    ds_read_b128 a[192:195], v2 offset:57344
    v_add_f32 v136, v136, v131
    v_mfma_f32_16x16x32_bf16 a[20:23], a[196:199], v[100:103], a[20:23]
    v_exp_f32 v132, v20
    v_mfma_f32_16x16x32_bf16 a[24:27], a[196:199], v[104:107], a[24:27]
    v_cvt_pk_bf16_f32 v81, v130, v131
    v_add_f32 v145, v145, v141
    v_mfma_f32_16x16x32_bf16 a[28:31], a[196:199], v[108:111], a[28:31]
    s_waitcnt lgkmcnt(6)
    v_exp_f32 v133, v21
    v_mfma_f32_16x16x32_bf16 a[32:35], a[200:203], v[96:99], a[32:35]
    ds_read_b128 a[196:199], v2 offset:58368
    v_add_f32 v137, v132, v133
    v_mfma_f32_16x16x32_bf16 a[36:39], a[200:203], v[100:103], a[36:39]
    v_exp_f32 v134, v22
    v_mfma_f32_16x16x32_bf16 a[40:43], a[200:203], v[104:107], a[40:43]
    v_cvt_pk_bf16_f32 v84, v132, v133
    v_add_f32 v137, v137, v134
    v_mfma_f32_16x16x32_bf16 a[44:47], a[200:203], v[108:111], a[44:47]
    s_waitcnt lgkmcnt(6)
    v_exp_f32 v135, v23
    v_mfma_f32_16x16x32_bf16 a[48:51], a[204:207], v[96:99], a[48:51]
    ds_read_b128 a[200:203], v2 offset:59392
    v_add_f32 v137, v137, v135
    v_mfma_f32_16x16x32_bf16 a[52:55], a[204:207], v[100:103], a[52:55]
    v_exp_f32 v128, v24
    v_mfma_f32_16x16x32_bf16 a[56:59], a[204:207], v[104:107], a[56:59]
    v_cvt_pk_bf16_f32 v85, v134, v135
    v_add_f32 v146, v146, v142
    v_mfma_f32_16x16x32_bf16 a[60:63], a[204:207], v[108:111], a[60:63]
    s_waitcnt lgkmcnt(6)
    v_exp_f32 v129, v25
    v_mfma_f32_16x16x32_bf16 a[64:67], a[208:211], v[96:99], a[64:67]
    ds_read_b128 a[204:207], v2 offset:60416
    v_add_f32 v138, v128, v129
    v_mfma_f32_16x16x32_bf16 a[68:71], a[208:211], v[100:103], a[68:71]
    v_exp_f32 v130, v26
    v_mfma_f32_16x16x32_bf16 a[72:75], a[208:211], v[104:107], a[72:75]
    s_waitcnt vmcnt(8)
    s_barrier
    v_cvt_pk_bf16_f32 v88, v128, v129
    v_add_f32 v138, v138, v130
    v_mfma_f32_16x16x32_bf16 a[76:79], a[208:211], v[108:111], a[76:79]
    s_waitcnt lgkmcnt(6)
    v_exp_f32 v131, v27
    v_mfma_f32_16x16x32_bf16 a[80:83], a[212:215], v[96:99], a[80:83]
    s_add_u32 s19, s23, s22
    s_add_u32 s21, s19, 4096
    s_add_u32 s22, s22, 16384
    s_and_b32 s22, s22, 0x7ffff
    s_add_u32 m0, s20, 65536
    ds_read_b128 a[208:211], v2 offset:61440
    v_add_f32 v138, v138, v131
    v_mfma_f32_16x16x32_bf16 a[84:87], a[212:215], v[100:103], a[84:87]
    buffer_load_dwordx4 v1, s[8:11], s19 offen offset:0 sc1 lds
    v_exp_f32 v132, v28
    v_mfma_f32_16x16x32_bf16 a[88:91], a[212:215], v[104:107], a[88:91]
    v_cvt_pk_bf16_f32 v89, v130, v131
    v_add_f32 v147, v147, v143
    v_mfma_f32_16x16x32_bf16 a[92:95], a[212:215], v[108:111], a[92:95]
    s_waitcnt lgkmcnt(6)
    v_exp_f32 v133, v29
    v_mfma_f32_16x16x32_bf16 a[96:99], a[216:219], v[96:99], a[96:99]
    ds_read_b128 a[212:215], v2 offset:62464
    v_add_f32 v139, v132, v133
    v_mfma_f32_16x16x32_bf16 a[100:103], a[216:219], v[100:103], a[100:103]
    buffer_load_dwordx4 v1, s[8:11], s19 offen offset:1024 sc1 lds
    v_exp_f32 v134, v30
    v_mfma_f32_16x16x32_bf16 a[104:107], a[216:219], v[104:107], a[104:107]
    v_cvt_pk_bf16_f32 v92, v132, v133
    v_add_f32 v139, v139, v134
    v_mfma_f32_16x16x32_bf16 a[108:111], a[216:219], v[108:111], a[108:111]
    s_waitcnt lgkmcnt(6)
    v_exp_f32 v135, v31
    v_mfma_f32_16x16x32_bf16 a[112:115], a[220:223], v[96:99], a[112:115]
    ds_read_b128 a[216:219], v2 offset:63488
    v_add_f32 v139, v139, v135
    v_mfma_f32_16x16x32_bf16 a[116:119], a[220:223], v[100:103], a[116:119]
    buffer_load_dwordx4 v1, s[8:11], s19 offen offset:2048 sc1 lds
    v_exp_f32 v128, v32
    v_mfma_f32_16x16x32_bf16 a[120:123], a[220:223], v[104:107], a[120:123]
    v_cvt_pk_bf16_f32 v93, v134, v135
    v_add_f32 v136, v136, v128
    v_mfma_f32_16x16x32_bf16 a[124:127], a[220:223], v[108:111], a[124:127]
    s_waitcnt lgkmcnt(6)
    v_exp_f32 v129, v33
    v_mfma_f32_16x16x32_bf16 v[48:51], a[192:195], a[128:131], v[112:115]
    ds_read_b128 a[220:223], v2 offset:64512
    v_add_f32 v136, v136, v129
    v_mfma_f32_16x16x32_bf16 v[52:55], a[192:195], a[144:147], v[116:119]
    buffer_load_dwordx4 v1, s[8:11], s19 offen offset:3072 sc1 lds
    v_exp_f32 v130, v34
    v_mfma_f32_16x16x32_bf16 v[56:59], a[192:195], a[160:163], v[120:123]
    v_cvt_pk_bf16_f32 v82, v128, v129
    v_add_f32 v136, v136, v130
    v_mfma_f32_16x16x32_bf16 v[60:63], a[192:195], a[176:179], v[124:127]
    s_waitcnt lgkmcnt(6)
    v_exp_f32 v131, v35
    v_mfma_f32_16x16x32_bf16 v[48:51], a[196:199], a[132:135], v[48:51]
    s_add_u32 m0, s20, 69632
    ds_read_b128 a[192:195], v1 offset:0
    v_add_f32 v136, v136, v131
    v_mfma_f32_16x16x32_bf16 v[52:55], a[196:199], a[148:151], v[52:55]
    buffer_load_dwordx4 v1, s[8:11], s21 offen offset:0 sc1 lds
    v_exp_f32 v132, v36
    v_mfma_f32_16x16x32_bf16 v[56:59], a[196:199], a[164:167], v[56:59]
    v_cvt_pk_bf16_f32 v83, v130, v131
    v_add_f32 v137, v137, v132
    v_mfma_f32_16x16x32_bf16 v[60:63], a[196:199], a[180:183], v[60:63]
    s_waitcnt lgkmcnt(6)
    v_exp_f32 v133, v37
    v_mfma_f32_16x16x32_bf16 v[48:51], a[200:203], a[136:139], v[48:51]
    ds_read_b128 a[196:199], v1 offset:1024
    v_add_f32 v137, v137, v133
    v_mfma_f32_16x16x32_bf16 v[52:55], a[200:203], a[152:155], v[52:55]
    buffer_load_dwordx4 v1, s[8:11], s21 offen offset:1024 sc1 lds
    v_exp_f32 v134, v38
    v_mfma_f32_16x16x32_bf16 v[56:59], a[200:203], a[168:171], v[56:59]
    v_cvt_pk_bf16_f32 v86, v132, v133
    v_add_f32 v137, v137, v134
    v_mfma_f32_16x16x32_bf16 v[60:63], a[200:203], a[184:187], v[60:63]
    s_waitcnt lgkmcnt(6)
    v_exp_f32 v135, v39
    v_mfma_f32_16x16x32_bf16 v[48:51], a[204:207], a[140:143], v[48:51]
    ds_read_b128 a[200:203], v1 offset:2048
    v_add_f32 v137, v137, v135
    v_mfma_f32_16x16x32_bf16 v[52:55], a[204:207], a[156:159], v[52:55]
    buffer_load_dwordx4 v1, s[8:11], s21 offen offset:2048 sc1 lds
    v_exp_f32 v128, v40
    v_mfma_f32_16x16x32_bf16 v[56:59], a[204:207], a[172:175], v[56:59]
    v_cvt_pk_bf16_f32 v87, v134, v135
    v_add_f32 v138, v138, v128
    v_mfma_f32_16x16x32_bf16 v[60:63], a[204:207], a[188:191], v[60:63]
    s_waitcnt lgkmcnt(6)
    v_exp_f32 v129, v41
    v_mfma_f32_16x16x32_bf16 v[64:67], a[208:211], a[128:131], v[112:115]
    ds_read_b128 a[204:207], v1 offset:3072
    v_add_f32 v138, v138, v129
    v_mfma_f32_16x16x32_bf16 v[68:71], a[208:211], a[144:147], v[116:119]
    buffer_load_dwordx4 v1, s[8:11], s21 offen offset:3072 sc1 lds
    v_exp_f32 v130, v42
    v_mfma_f32_16x16x32_bf16 v[72:75], a[208:211], a[160:163], v[120:123]
    v_cvt_pk_bf16_f32 v90, v128, v129
    v_add_f32 v138, v138, v130
    v_mfma_f32_16x16x32_bf16 v[76:79], a[208:211], a[176:179], v[124:127]
    s_waitcnt lgkmcnt(6)
    v_exp_f32 v131, v43
    v_mfma_f32_16x16x32_bf16 v[64:67], a[212:215], a[132:135], v[64:67]
    ds_read_b128 a[208:211], v1 offset:4096
    v_add_f32 v138, v138, v131
    v_mfma_f32_16x16x32_bf16 v[68:71], a[212:215], a[148:151], v[68:71]
    v_exp_f32 v132, v44
    v_mfma_f32_16x16x32_bf16 v[72:75], a[212:215], a[164:167], v[72:75]
    v_cvt_pk_bf16_f32 v91, v130, v131
    v_add_f32 v139, v139, v132
    v_mfma_f32_16x16x32_bf16 v[76:79], a[212:215], a[180:183], v[76:79]
    s_waitcnt lgkmcnt(6)
    v_exp_f32 v133, v45
    v_mfma_f32_16x16x32_bf16 v[64:67], a[216:219], a[136:139], v[64:67]
    ds_read_b128 a[212:215], v1 offset:5120
    v_add_f32 v139, v139, v133
    v_mfma_f32_16x16x32_bf16 v[68:71], a[216:219], a[152:155], v[68:71]
    v_exp_f32 v134, v46
    v_max3_f32 v148, v136, v137, v138
    v_mfma_f32_16x16x32_bf16 v[72:75], a[216:219], a[168:171], v[72:75]
    v_cvt_pk_bf16_f32 v94, v132, v133
    v_add_f32 v139, v139, v134
    v_mfma_f32_16x16x32_bf16 v[76:79], a[216:219], a[184:187], v[76:79]
    s_waitcnt lgkmcnt(6)
    v_exp_f32 v135, v47
    v_mfma_f32_16x16x32_bf16 v[64:67], a[220:223], a[140:143], v[64:67]
    ds_read_b128 a[216:219], v1 offset:6144
    v_add_f32 v139, v139, v135
    v_mfma_f32_16x16x32_bf16 v[68:71], a[220:223], a[156:159], v[68:71]
    v_exp_f32 v128, v48
    v_max_f32 v148, v148, v139
    v_mfma_f32_16x16x32_bf16 v[72:75], a[220:223], a[172:175], v[72:75]
    v_cvt_pk_bf16_f32 v95, v134, v135
    v_cmp_lt_f32 vcc, s18, v148
    v_mfma_f32_16x16x32_bf16 v[76:79], a[220:223], a[188:191], v[76:79]
    s_waitcnt lgkmcnt(6)
    s_cbranch_vccnz L_tramp_7
L_back_7:
    v_exp_f32 v129, v49
    v_mfma_f32_16x16x32_bf16 a[0:3], a[192:195], v[80:83], a[0:3]
    ds_read_b128 a[220:223], v1 offset:7168
    v_add_f32 v140, v128, v129
    v_mfma_f32_16x16x32_bf16 a[4:7], a[192:195], v[84:87], a[4:7]
    v_exp_f32 v130, v50
    v_add_f32 v144, v144, v136
    v_mfma_f32_16x16x32_bf16 a[8:11], a[192:195], v[88:91], a[8:11]
    v_cvt_pk_bf16_f32 v96, v128, v129
    v_add_f32 v140, v140, v130
    v_mfma_f32_16x16x32_bf16 a[12:15], a[192:195], v[92:95], a[12:15]
    s_waitcnt lgkmcnt(6)
    v_exp_f32 v131, v51
    v_mfma_f32_16x16x32_bf16 a[16:19], a[196:199], v[80:83], a[16:19]
    ds_read_b128 a[192:195], v1 offset:8192
    v_add_f32 v140, v140, v131
    v_mfma_f32_16x16x32_bf16 a[20:23], a[196:199], v[84:87], a[20:23]
    v_exp_f32 v132, v52
    v_mfma_f32_16x16x32_bf16 a[24:27], a[196:199], v[88:91], a[24:27]
    v_cvt_pk_bf16_f32 v97, v130, v131
    v_add_f32 v145, v145, v137
    v_mfma_f32_16x16x32_bf16 a[28:31], a[196:199], v[92:95], a[28:31]
    s_waitcnt lgkmcnt(6)
    v_exp_f32 v133, v53
    v_mfma_f32_16x16x32_bf16 a[32:35], a[200:203], v[80:83], a[32:35]
    ds_read_b128 a[196:199], v1 offset:9216
    v_add_f32 v141, v132, v133
    v_mfma_f32_16x16x32_bf16 a[36:39], a[200:203], v[84:87], a[36:39]
    v_exp_f32 v134, v54
    v_mfma_f32_16x16x32_bf16 a[40:43], a[200:203], v[88:91], a[40:43]
    v_cvt_pk_bf16_f32 v100, v132, v133
    v_add_f32 v141, v141, v134
    v_mfma_f32_16x16x32_bf16 a[44:47], a[200:203], v[92:95], a[44:47]
    s_waitcnt lgkmcnt(6)
    v_exp_f32 v135, v55
    v_mfma_f32_16x16x32_bf16 a[48:51], a[204:207], v[80:83], a[48:51]
    ds_read_b128 a[200:203], v1 offset:10240
    v_add_f32 v141, v141, v135
    v_mfma_f32_16x16x32_bf16 a[52:55], a[204:207], v[84:87], a[52:55]
    v_exp_f32 v128, v56
    v_mfma_f32_16x16x32_bf16 a[56:59], a[204:207], v[88:91], a[56:59]
    v_cvt_pk_bf16_f32 v101, v134, v135
    v_add_f32 v146, v146, v138
    v_mfma_f32_16x16x32_bf16 a[60:63], a[204:207], v[92:95], a[60:63]
    s_waitcnt lgkmcnt(6)
    v_exp_f32 v129, v57
    v_mfma_f32_16x16x32_bf16 a[64:67], a[208:211], v[80:83], a[64:67]
    ds_read_b128 a[204:207], v1 offset:11264
    v_add_f32 v142, v128, v129
    v_mfma_f32_16x16x32_bf16 a[68:71], a[208:211], v[84:87], a[68:71]
    v_exp_f32 v130, v58
    v_mfma_f32_16x16x32_bf16 a[72:75], a[208:211], v[88:91], a[72:75]
    v_cvt_pk_bf16_f32 v104, v128, v129
    v_add_f32 v142, v142, v130
    v_mfma_f32_16x16x32_bf16 a[76:79], a[208:211], v[92:95], a[76:79]
    s_waitcnt lgkmcnt(6)
    v_exp_f32 v131, v59
    v_mfma_f32_16x16x32_bf16 a[80:83], a[212:215], v[80:83], a[80:83]
    ds_read_b128 a[208:211], v1 offset:12288
    v_add_f32 v142, v142, v131
    v_mfma_f32_16x16x32_bf16 a[84:87], a[212:215], v[84:87], a[84:87]
    v_exp_f32 v132, v60
    v_mfma_f32_16x16x32_bf16 a[88:91], a[212:215], v[88:91], a[88:91]
    v_cvt_pk_bf16_f32 v105, v130, v131
    v_add_f32 v147, v147, v139
    v_mfma_f32_16x16x32_bf16 a[92:95], a[212:215], v[92:95], a[92:95]
    s_waitcnt lgkmcnt(6)
    v_exp_f32 v133, v61
    v_mfma_f32_16x16x32_bf16 a[96:99], a[216:219], v[80:83], a[96:99]
    ds_read_b128 a[212:215], v1 offset:13312
    v_add_f32 v143, v132, v133
    v_mfma_f32_16x16x32_bf16 a[100:103], a[216:219], v[84:87], a[100:103]
    v_exp_f32 v134, v62
    v_mfma_f32_16x16x32_bf16 a[104:107], a[216:219], v[88:91], a[104:107]
    v_cvt_pk_bf16_f32 v108, v132, v133
    v_add_f32 v143, v143, v134
    v_mfma_f32_16x16x32_bf16 a[108:111], a[216:219], v[92:95], a[108:111]
    s_waitcnt lgkmcnt(6)
    v_exp_f32 v135, v63
    v_mfma_f32_16x16x32_bf16 a[112:115], a[220:223], v[80:83], a[112:115]
    ds_read_b128 a[216:219], v1 offset:14336
    v_add_f32 v143, v143, v135
    v_mfma_f32_16x16x32_bf16 a[116:119], a[220:223], v[84:87], a[116:119]
    v_exp_f32 v128, v64
    v_mfma_f32_16x16x32_bf16 a[120:123], a[220:223], v[88:91], a[120:123]
    v_cvt_pk_bf16_f32 v109, v134, v135
    v_add_f32 v140, v140, v128
    v_mfma_f32_16x16x32_bf16 a[124:127], a[220:223], v[92:95], a[124:127]
    s_waitcnt lgkmcnt(6)
    v_exp_f32 v129, v65
    v_mfma_f32_16x16x32_bf16 v[16:19], a[192:195], a[128:131], v[112:115]
    ds_read_b128 a[220:223], v1 offset:15360
    v_add_f32 v140, v140, v129
    v_mfma_f32_16x16x32_bf16 v[20:23], a[192:195], a[144:147], v[116:119]
    v_exp_f32 v130, v66
    v_mfma_f32_16x16x32_bf16 v[24:27], a[192:195], a[160:163], v[120:123]
    v_cvt_pk_bf16_f32 v98, v128, v129
    v_add_f32 v140, v140, v130
    v_mfma_f32_16x16x32_bf16 v[28:31], a[192:195], a[176:179], v[124:127]
    s_waitcnt lgkmcnt(6)
    v_exp_f32 v131, v67
    v_mfma_f32_16x16x32_bf16 v[16:19], a[196:199], a[132:135], v[16:19]
    ds_read_b128 a[192:195], v1 offset:16384
    v_add_f32 v140, v140, v131
    v_mfma_f32_16x16x32_bf16 v[20:23], a[196:199], a[148:151], v[20:23]
    v_exp_f32 v132, v68
    v_mfma_f32_16x16x32_bf16 v[24:27], a[196:199], a[164:167], v[24:27]
    v_cvt_pk_bf16_f32 v99, v130, v131
    v_add_f32 v141, v141, v132
    v_mfma_f32_16x16x32_bf16 v[28:31], a[196:199], a[180:183], v[28:31]
    s_waitcnt lgkmcnt(6)
    v_exp_f32 v133, v69
    v_mfma_f32_16x16x32_bf16 v[16:19], a[200:203], a[136:139], v[16:19]
    ds_read_b128 a[196:199], v1 offset:17408
    v_add_f32 v141, v141, v133
    v_mfma_f32_16x16x32_bf16 v[20:23], a[200:203], a[152:155], v[20:23]
    v_exp_f32 v134, v70
    v_mfma_f32_16x16x32_bf16 v[24:27], a[200:203], a[168:171], v[24:27]
    v_cvt_pk_bf16_f32 v102, v132, v133
    v_add_f32 v141, v141, v134
    v_mfma_f32_16x16x32_bf16 v[28:31], a[200:203], a[184:187], v[28:31]
    s_waitcnt lgkmcnt(6)
    v_exp_f32 v135, v71
    v_mfma_f32_16x16x32_bf16 v[16:19], a[204:207], a[140:143], v[16:19]
    ds_read_b128 a[200:203], v1 offset:18432
    v_add_f32 v141, v141, v135
    v_mfma_f32_16x16x32_bf16 v[20:23], a[204:207], a[156:159], v[20:23]
    v_exp_f32 v128, v72
    v_mfma_f32_16x16x32_bf16 v[24:27], a[204:207], a[172:175], v[24:27]
    v_cvt_pk_bf16_f32 v103, v134, v135
    v_add_f32 v142, v142, v128
    v_mfma_f32_16x16x32_bf16 v[28:31], a[204:207], a[188:191], v[28:31]
    s_waitcnt lgkmcnt(6)
    v_exp_f32 v129, v73
    v_mfma_f32_16x16x32_bf16 v[32:35], a[208:211], a[128:131], v[112:115]
    ds_read_b128 a[204:207], v1 offset:19456
    v_add_f32 v142, v142, v129
    v_mfma_f32_16x16x32_bf16 v[36:39], a[208:211], a[144:147], v[116:119]
    v_exp_f32 v130, v74
    v_mfma_f32_16x16x32_bf16 v[40:43], a[208:211], a[160:163], v[120:123]
    v_cvt_pk_bf16_f32 v106, v128, v129
    v_add_f32 v142, v142, v130
    v_mfma_f32_16x16x32_bf16 v[44:47], a[208:211], a[176:179], v[124:127]
    s_waitcnt lgkmcnt(6)
    v_exp_f32 v131, v75
    v_mfma_f32_16x16x32_bf16 v[32:35], a[212:215], a[132:135], v[32:35]
    ds_read_b128 a[208:211], v1 offset:20480
    v_add_f32 v142, v142, v131
    v_mfma_f32_16x16x32_bf16 v[36:39], a[212:215], a[148:151], v[36:39]
    v_exp_f32 v132, v76
    v_mfma_f32_16x16x32_bf16 v[40:43], a[212:215], a[164:167], v[40:43]
    v_cvt_pk_bf16_f32 v107, v130, v131
    v_add_f32 v143, v143, v132
    v_mfma_f32_16x16x32_bf16 v[44:47], a[212:215], a[180:183], v[44:47]
    s_waitcnt lgkmcnt(6)
    v_exp_f32 v133, v77
    v_mfma_f32_16x16x32_bf16 v[32:35], a[216:219], a[136:139], v[32:35]
    ds_read_b128 a[212:215], v1 offset:21504
    v_add_f32 v143, v143, v133
    v_mfma_f32_16x16x32_bf16 v[36:39], a[216:219], a[152:155], v[36:39]
    v_exp_f32 v134, v78
    v_max3_f32 v148, v140, v141, v142
    v_mfma_f32_16x16x32_bf16 v[40:43], a[216:219], a[168:171], v[40:43]
    v_cvt_pk_bf16_f32 v110, v132, v133
    v_add_f32 v143, v143, v134
    v_mfma_f32_16x16x32_bf16 v[44:47], a[216:219], a[184:187], v[44:47]
    s_waitcnt lgkmcnt(6)
    v_exp_f32 v135, v79
    v_mfma_f32_16x16x32_bf16 v[32:35], a[220:223], a[140:143], v[32:35]
    ds_read_b128 a[216:219], v1 offset:22528
    v_add_f32 v143, v143, v135
    v_mfma_f32_16x16x32_bf16 v[36:39], a[220:223], a[156:159], v[36:39]
    v_exp_f32 v128, v16
    v_max_f32 v148, v148, v143
    v_mfma_f32_16x16x32_bf16 v[40:43], a[220:223], a[172:175], v[40:43]
    v_cvt_pk_bf16_f32 v111, v134, v135
    v_cmp_lt_f32 vcc, s18, v148
    v_mfma_f32_16x16x32_bf16 v[44:47], a[220:223], a[188:191], v[44:47]
    s_waitcnt lgkmcnt(6)
    s_cbranch_vccnz L_tramp_8
L_back_8:
    v_exp_f32 v129, v17
    v_mfma_f32_16x16x32_bf16 a[0:3], a[192:195], v[96:99], a[0:3]
    ds_read_b128 a[220:223], v1 offset:23552
    v_add_f32 v136, v128, v129
    v_mfma_f32_16x16x32_bf16 a[4:7], a[192:195], v[100:103], a[4:7]
    v_exp_f32 v130, v18
    v_add_f32 v144, v144, v140
    v_mfma_f32_16x16x32_bf16 a[8:11], a[192:195], v[104:107], a[8:11]
    v_cvt_pk_bf16_f32 v80, v128, v129
    v_add_f32 v136, v136, v130
    v_mfma_f32_16x16x32_bf16 a[12:15], a[192:195], v[108:111], a[12:15]
    s_waitcnt lgkmcnt(6)
    v_exp_f32 v131, v19
    v_mfma_f32_16x16x32_bf16 a[16:19], a[196:199], v[96:99], a[16:19]
    ds_read_b128 a[192:195], v1 offset:24576
    v_add_f32 v136, v136, v131
    v_mfma_f32_16x16x32_bf16 a[20:23], a[196:199], v[100:103], a[20:23]
    v_exp_f32 v132, v20
    v_mfma_f32_16x16x32_bf16 a[24:27], a[196:199], v[104:107], a[24:27]
    v_cvt_pk_bf16_f32 v81, v130, v131
    v_add_f32 v145, v145, v141
    v_mfma_f32_16x16x32_bf16 a[28:31], a[196:199], v[108:111], a[28:31]
    s_waitcnt lgkmcnt(6)
    v_exp_f32 v133, v21
    v_mfma_f32_16x16x32_bf16 a[32:35], a[200:203], v[96:99], a[32:35]
    ds_read_b128 a[196:199], v1 offset:25600
    v_add_f32 v137, v132, v133
    v_mfma_f32_16x16x32_bf16 a[36:39], a[200:203], v[100:103], a[36:39]
    v_exp_f32 v134, v22
    v_mfma_f32_16x16x32_bf16 a[40:43], a[200:203], v[104:107], a[40:43]
    v_cvt_pk_bf16_f32 v84, v132, v133
    v_add_f32 v137, v137, v134
    v_mfma_f32_16x16x32_bf16 a[44:47], a[200:203], v[108:111], a[44:47]
    s_waitcnt lgkmcnt(6)
    v_exp_f32 v135, v23
    v_mfma_f32_16x16x32_bf16 a[48:51], a[204:207], v[96:99], a[48:51]
    ds_read_b128 a[200:203], v1 offset:26624
    v_add_f32 v137, v137, v135
    v_mfma_f32_16x16x32_bf16 a[52:55], a[204:207], v[100:103], a[52:55]
    v_exp_f32 v128, v24
    v_mfma_f32_16x16x32_bf16 a[56:59], a[204:207], v[104:107], a[56:59]
    v_cvt_pk_bf16_f32 v85, v134, v135
    v_add_f32 v146, v146, v142
    v_mfma_f32_16x16x32_bf16 a[60:63], a[204:207], v[108:111], a[60:63]
    s_waitcnt lgkmcnt(6)
    v_exp_f32 v129, v25
    v_mfma_f32_16x16x32_bf16 a[64:67], a[208:211], v[96:99], a[64:67]
    ds_read_b128 a[204:207], v1 offset:27648
    v_add_f32 v138, v128, v129
    v_mfma_f32_16x16x32_bf16 a[68:71], a[208:211], v[100:103], a[68:71]
    v_exp_f32 v130, v26
    v_mfma_f32_16x16x32_bf16 a[72:75], a[208:211], v[104:107], a[72:75]
    s_waitcnt vmcnt(8)
    s_barrier
    v_cvt_pk_bf16_f32 v88, v128, v129
    v_add_f32 v138, v138, v130
    v_mfma_f32_16x16x32_bf16 a[76:79], a[208:211], v[108:111], a[76:79]
    s_waitcnt lgkmcnt(6)
    v_exp_f32 v131, v27
    v_mfma_f32_16x16x32_bf16 a[80:83], a[212:215], v[96:99], a[80:83]
    s_add_u32 s19, s23, s22
    s_add_u32 s21, s19, 4096
    s_add_u32 s22, s22, 16384
    s_and_b32 s22, s22, 0x7ffff
    s_add_u32 m0, s20, 98304
    ds_read_b128 a[208:211], v1 offset:28672
    v_add_f32 v138, v138, v131
    v_mfma_f32_16x16x32_bf16 a[84:87], a[212:215], v[100:103], a[84:87]
    buffer_load_dwordx4 v1, s[8:11], s19 offen offset:0 sc1 lds
    v_exp_f32 v132, v28
    v_mfma_f32_16x16x32_bf16 a[88:91], a[212:215], v[104:107], a[88:91]
    v_cvt_pk_bf16_f32 v89, v130, v131
    v_add_f32 v147, v147, v143
    v_mfma_f32_16x16x32_bf16 a[92:95], a[212:215], v[108:111], a[92:95]
    s_waitcnt lgkmcnt(6)
    v_exp_f32 v133, v29
    v_mfma_f32_16x16x32_bf16 a[96:99], a[216:219], v[96:99], a[96:99]
    ds_read_b128 a[212:215], v1 offset:29696
    v_add_f32 v139, v132, v133
    v_mfma_f32_16x16x32_bf16 a[100:103], a[216:219], v[100:103], a[100:103]
    buffer_load_dwordx4 v1, s[8:11], s19 offen offset:1024 sc1 lds
    v_exp_f32 v134, v30
    v_mfma_f32_16x16x32_bf16 a[104:107], a[216:219], v[104:107], a[104:107]
    v_cvt_pk_bf16_f32 v92, v132, v133
    v_add_f32 v139, v139, v134
    v_mfma_f32_16x16x32_bf16 a[108:111], a[216:219], v[108:111], a[108:111]
    s_waitcnt lgkmcnt(6)
    v_exp_f32 v135, v31
    v_mfma_f32_16x16x32_bf16 a[112:115], a[220:223], v[96:99], a[112:115]
    ds_read_b128 a[216:219], v1 offset:30720
    v_add_f32 v139, v139, v135
    v_mfma_f32_16x16x32_bf16 a[116:119], a[220:223], v[100:103], a[116:119]
    buffer_load_dwordx4 v1, s[8:11], s19 offen offset:2048 sc1 lds
    v_exp_f32 v128, v32
    v_mfma_f32_16x16x32_bf16 a[120:123], a[220:223], v[104:107], a[120:123]
    v_cvt_pk_bf16_f32 v93, v134, v135
    v_add_f32 v136, v136, v128
    v_mfma_f32_16x16x32_bf16 a[124:127], a[220:223], v[108:111], a[124:127]
    s_waitcnt lgkmcnt(6)
    v_exp_f32 v129, v33
    v_mfma_f32_16x16x32_bf16 v[48:51], a[192:195], a[128:131], v[112:115]
    ds_read_b128 a[220:223], v1 offset:31744
    v_add_f32 v136, v136, v129
    v_mfma_f32_16x16x32_bf16 v[52:55], a[192:195], a[144:147], v[116:119]
    buffer_load_dwordx4 v1, s[8:11], s19 offen offset:3072 sc1 lds
    v_exp_f32 v130, v34
    v_mfma_f32_16x16x32_bf16 v[56:59], a[192:195], a[160:163], v[120:123]
    v_cvt_pk_bf16_f32 v82, v128, v129
    v_add_f32 v136, v136, v130
    v_mfma_f32_16x16x32_bf16 v[60:63], a[192:195], a[176:179], v[124:127]
    s_waitcnt lgkmcnt(6)
    v_exp_f32 v131, v35
    v_mfma_f32_16x16x32_bf16 v[48:51], a[196:199], a[132:135], v[48:51]
    s_add_u32 m0, s20, 102400
    ds_read_b128 a[192:195], v1 offset:32768
    v_add_f32 v136, v136, v131
    v_mfma_f32_16x16x32_bf16 v[52:55], a[196:199], a[148:151], v[52:55]
    buffer_load_dwordx4 v1, s[8:11], s21 offen offset:0 sc1 lds
    v_exp_f32 v132, v36
    v_mfma_f32_16x16x32_bf16 v[56:59], a[196:199], a[164:167], v[56:59]
    v_cvt_pk_bf16_f32 v83, v130, v131
    v_add_f32 v137, v137, v132
    v_mfma_f32_16x16x32_bf16 v[60:63], a[196:199], a[180:183], v[60:63]
    s_waitcnt lgkmcnt(6)
    v_exp_f32 v133, v37
    v_mfma_f32_16x16x32_bf16 v[48:51], a[200:203], a[136:139], v[48:51]
    ds_read_b128 a[196:199], v1 offset:33792
    v_add_f32 v137, v137, v133
    v_mfma_f32_16x16x32_bf16 v[52:55], a[200:203], a[152:155], v[52:55]
    buffer_load_dwordx4 v1, s[8:11], s21 offen offset:1024 sc1 lds
    v_exp_f32 v134, v38
    v_mfma_f32_16x16x32_bf16 v[56:59], a[200:203], a[168:171], v[56:59]
    v_cvt_pk_bf16_f32 v86, v132, v133
    v_add_f32 v137, v137, v134
    v_mfma_f32_16x16x32_bf16 v[60:63], a[200:203], a[184:187], v[60:63]
    s_waitcnt lgkmcnt(6)
    v_exp_f32 v135, v39
    v_mfma_f32_16x16x32_bf16 v[48:51], a[204:207], a[140:143], v[48:51]
    ds_read_b128 a[200:203], v1 offset:34816
    v_add_f32 v137, v137, v135
    v_mfma_f32_16x16x32_bf16 v[52:55], a[204:207], a[156:159], v[52:55]
    buffer_load_dwordx4 v1, s[8:11], s21 offen offset:2048 sc1 lds
    v_exp_f32 v128, v40
    v_mfma_f32_16x16x32_bf16 v[56:59], a[204:207], a[172:175], v[56:59]
    v_cvt_pk_bf16_f32 v87, v134, v135
    v_add_f32 v138, v138, v128
    v_mfma_f32_16x16x32_bf16 v[60:63], a[204:207], a[188:191], v[60:63]
    s_waitcnt lgkmcnt(6)
    v_exp_f32 v129, v41
    v_mfma_f32_16x16x32_bf16 v[64:67], a[208:211], a[128:131], v[112:115]
    ds_read_b128 a[204:207], v1 offset:35840
    v_add_f32 v138, v138, v129
    v_mfma_f32_16x16x32_bf16 v[68:71], a[208:211], a[144:147], v[116:119]
    buffer_load_dwordx4 v1, s[8:11], s21 offen offset:3072 sc1 lds
    v_exp_f32 v130, v42
    v_mfma_f32_16x16x32_bf16 v[72:75], a[208:211], a[160:163], v[120:123]
    v_cvt_pk_bf16_f32 v90, v128, v129
    v_add_f32 v138, v138, v130
    v_mfma_f32_16x16x32_bf16 v[76:79], a[208:211], a[176:179], v[124:127]
    s_waitcnt lgkmcnt(6)
    v_exp_f32 v131, v43
    v_mfma_f32_16x16x32_bf16 v[64:67], a[212:215], a[132:135], v[64:67]
    ds_read_b128 a[208:211], v1 offset:36864
    v_add_f32 v138, v138, v131
    v_mfma_f32_16x16x32_bf16 v[68:71], a[212:215], a[148:151], v[68:71]
    v_exp_f32 v132, v44
    v_mfma_f32_16x16x32_bf16 v[72:75], a[212:215], a[164:167], v[72:75]
    v_cvt_pk_bf16_f32 v91, v130, v131
    v_add_f32 v139, v139, v132
    v_mfma_f32_16x16x32_bf16 v[76:79], a[212:215], a[180:183], v[76:79]
    s_waitcnt lgkmcnt(6)
    v_exp_f32 v133, v45
    v_mfma_f32_16x16x32_bf16 v[64:67], a[216:219], a[136:139], v[64:67]
    ds_read_b128 a[212:215], v1 offset:37888
    v_add_f32 v139, v139, v133
    v_mfma_f32_16x16x32_bf16 v[68:71], a[216:219], a[152:155], v[68:71]
    v_exp_f32 v134, v46
    v_max3_f32 v148, v136, v137, v138
    v_mfma_f32_16x16x32_bf16 v[72:75], a[216:219], a[168:171], v[72:75]
    v_cvt_pk_bf16_f32 v94, v132, v133
    v_add_f32 v139, v139, v134
    v_mfma_f32_16x16x32_bf16 v[76:79], a[216:219], a[184:187], v[76:79]
    s_waitcnt lgkmcnt(6)
    v_exp_f32 v135, v47
    v_mfma_f32_16x16x32_bf16 v[64:67], a[220:223], a[140:143], v[64:67]
    ds_read_b128 a[216:219], v1 offset:38912
    v_add_f32 v139, v139, v135
    v_mfma_f32_16x16x32_bf16 v[68:71], a[220:223], a[156:159], v[68:71]
    v_exp_f32 v128, v48
    v_max_f32 v148, v148, v139
    v_mfma_f32_16x16x32_bf16 v[72:75], a[220:223], a[172:175], v[72:75]
    v_cvt_pk_bf16_f32 v95, v134, v135
    v_cmp_lt_f32 vcc, s18, v148
    v_mfma_f32_16x16x32_bf16 v[76:79], a[220:223], a[188:191], v[76:79]
    s_waitcnt lgkmcnt(6)
    s_cbranch_vccnz L_tramp_9
L_back_9:
    v_exp_f32 v129, v49
    s_add_u32 s17, s17, 1
    s_cmp_lt_u32 s17, 7
    s_cbranch_scc1 L_loop
    v_mfma_f32_16x16x32_bf16 a[0:3], a[192:195], v[80:83], a[0:3]
    ds_read_b128 a[220:223], v1 offset:39936
    v_add_f32 v140, v128, v129
    v_mfma_f32_16x16x32_bf16 a[4:7], a[192:195], v[84:87], a[4:7]
    v_exp_f32 v130, v50
    v_add_f32 v144, v144, v136
    v_mfma_f32_16x16x32_bf16 a[8:11], a[192:195], v[88:91], a[8:11]
    v_cvt_pk_bf16_f32 v96, v128, v129
    v_add_f32 v140, v140, v130
    v_mfma_f32_16x16x32_bf16 a[12:15], a[192:195], v[92:95], a[12:15]
    s_waitcnt lgkmcnt(6)
    v_exp_f32 v131, v51
    v_mfma_f32_16x16x32_bf16 a[16:19], a[196:199], v[80:83], a[16:19]
    ds_read_b128 a[192:195], v1 offset:40960
    v_add_f32 v140, v140, v131
    v_mfma_f32_16x16x32_bf16 a[20:23], a[196:199], v[84:87], a[20:23]
    v_exp_f32 v132, v52
    v_mfma_f32_16x16x32_bf16 a[24:27], a[196:199], v[88:91], a[24:27]
    v_cvt_pk_bf16_f32 v97, v130, v131
    v_add_f32 v145, v145, v137
    v_mfma_f32_16x16x32_bf16 a[28:31], a[196:199], v[92:95], a[28:31]
    s_waitcnt lgkmcnt(6)
    v_exp_f32 v133, v53
    v_mfma_f32_16x16x32_bf16 a[32:35], a[200:203], v[80:83], a[32:35]
    ds_read_b128 a[196:199], v1 offset:41984
    v_add_f32 v141, v132, v133
    v_mfma_f32_16x16x32_bf16 a[36:39], a[200:203], v[84:87], a[36:39]
    v_exp_f32 v134, v54
    v_mfma_f32_16x16x32_bf16 a[40:43], a[200:203], v[88:91], a[40:43]
    v_cvt_pk_bf16_f32 v100, v132, v133
    v_add_f32 v141, v141, v134
    v_mfma_f32_16x16x32_bf16 a[44:47], a[200:203], v[92:95], a[44:47]
    s_waitcnt lgkmcnt(6)
    v_exp_f32 v135, v55
    v_mfma_f32_16x16x32_bf16 a[48:51], a[204:207], v[80:83], a[48:51]
    ds_read_b128 a[200:203], v1 offset:43008
    v_add_f32 v141, v141, v135
    v_mfma_f32_16x16x32_bf16 a[52:55], a[204:207], v[84:87], a[52:55]
    v_exp_f32 v128, v56
    v_mfma_f32_16x16x32_bf16 a[56:59], a[204:207], v[88:91], a[56:59]
    v_cvt_pk_bf16_f32 v101, v134, v135
    v_add_f32 v146, v146, v138
    v_mfma_f32_16x16x32_bf16 a[60:63], a[204:207], v[92:95], a[60:63]
    s_waitcnt lgkmcnt(6)
    v_exp_f32 v129, v57
    v_mfma_f32_16x16x32_bf16 a[64:67], a[208:211], v[80:83], a[64:67]
    ds_read_b128 a[204:207], v1 offset:44032
    v_add_f32 v142, v128, v129
    v_mfma_f32_16x16x32_bf16 a[68:71], a[208:211], v[84:87], a[68:71]
    v_exp_f32 v130, v58
    v_mfma_f32_16x16x32_bf16 a[72:75], a[208:211], v[88:91], a[72:75]
    v_cvt_pk_bf16_f32 v104, v128, v129
    v_add_f32 v142, v142, v130
    v_mfma_f32_16x16x32_bf16 a[76:79], a[208:211], v[92:95], a[76:79]
    s_waitcnt lgkmcnt(6)
    v_exp_f32 v131, v59
    v_mfma_f32_16x16x32_bf16 a[80:83], a[212:215], v[80:83], a[80:83]
    ds_read_b128 a[208:211], v1 offset:45056
    v_add_f32 v142, v142, v131
    v_mfma_f32_16x16x32_bf16 a[84:87], a[212:215], v[84:87], a[84:87]
    v_exp_f32 v132, v60
    v_mfma_f32_16x16x32_bf16 a[88:91], a[212:215], v[88:91], a[88:91]
    v_cvt_pk_bf16_f32 v105, v130, v131
    v_add_f32 v147, v147, v139
    v_mfma_f32_16x16x32_bf16 a[92:95], a[212:215], v[92:95], a[92:95]
    s_waitcnt lgkmcnt(6)
    v_exp_f32 v133, v61
    v_mfma_f32_16x16x32_bf16 a[96:99], a[216:219], v[80:83], a[96:99]
    ds_read_b128 a[212:215], v1 offset:46080
    v_add_f32 v143, v132, v133
    v_mfma_f32_16x16x32_bf16 a[100:103], a[216:219], v[84:87], a[100:103]
    v_exp_f32 v134, v62
    v_mfma_f32_16x16x32_bf16 a[104:107], a[216:219], v[88:91], a[104:107]
    v_cvt_pk_bf16_f32 v108, v132, v133
    v_add_f32 v143, v143, v134
    v_mfma_f32_16x16x32_bf16 a[108:111], a[216:219], v[92:95], a[108:111]
    s_waitcnt lgkmcnt(6)
    v_exp_f32 v135, v63
    v_mfma_f32_16x16x32_bf16 a[112:115], a[220:223], v[80:83], a[112:115]
    ds_read_b128 a[216:219], v1 offset:47104
    v_add_f32 v143, v143, v135
    v_mfma_f32_16x16x32_bf16 a[116:119], a[220:223], v[84:87], a[116:119]
    v_exp_f32 v128, v64
    v_mfma_f32_16x16x32_bf16 a[120:123], a[220:223], v[88:91], a[120:123]
    v_cvt_pk_bf16_f32 v109, v134, v135
    v_add_f32 v140, v140, v128
    v_mfma_f32_16x16x32_bf16 a[124:127], a[220:223], v[92:95], a[124:127]
    s_waitcnt lgkmcnt(6)
    v_exp_f32 v129, v65
    v_mfma_f32_16x16x32_bf16 v[16:19], a[192:195], a[128:131], v[112:115]
    ds_read_b128 a[220:223], v1 offset:48128
    v_add_f32 v140, v140, v129
    v_mfma_f32_16x16x32_bf16 v[20:23], a[192:195], a[144:147], v[116:119]
    v_exp_f32 v130, v66
    v_mfma_f32_16x16x32_bf16 v[24:27], a[192:195], a[160:163], v[120:123]
    v_cvt_pk_bf16_f32 v98, v128, v129
    v_add_f32 v140, v140, v130
    v_mfma_f32_16x16x32_bf16 v[28:31], a[192:195], a[176:179], v[124:127]
    s_waitcnt lgkmcnt(6)
    v_exp_f32 v131, v67
    v_mfma_f32_16x16x32_bf16 v[16:19], a[196:199], a[132:135], v[16:19]
    ds_read_b128 a[192:195], v1 offset:49152
    v_add_f32 v140, v140, v131
    v_mfma_f32_16x16x32_bf16 v[20:23], a[196:199], a[148:151], v[20:23]
    v_exp_f32 v132, v68
    v_mfma_f32_16x16x32_bf16 v[24:27], a[196:199], a[164:167], v[24:27]
    v_cvt_pk_bf16_f32 v99, v130, v131
    v_add_f32 v141, v141, v132
    v_mfma_f32_16x16x32_bf16 v[28:31], a[196:199], a[180:183], v[28:31]
    s_waitcnt lgkmcnt(6)
    v_exp_f32 v133, v69
    v_mfma_f32_16x16x32_bf16 v[16:19], a[200:203], a[136:139], v[16:19]
    ds_read_b128 a[196:199], v1 offset:50176
    v_add_f32 v141, v141, v133
    v_mfma_f32_16x16x32_bf16 v[20:23], a[200:203], a[152:155], v[20:23]
    v_exp_f32 v134, v70
    v_mfma_f32_16x16x32_bf16 v[24:27], a[200:203], a[168:171], v[24:27]
    v_cvt_pk_bf16_f32 v102, v132, v133
    v_add_f32 v141, v141, v134
    v_mfma_f32_16x16x32_bf16 v[28:31], a[200:203], a[184:187], v[28:31]
    s_waitcnt lgkmcnt(6)
    v_exp_f32 v135, v71
    v_mfma_f32_16x16x32_bf16 v[16:19], a[204:207], a[140:143], v[16:19]
    ds_read_b128 a[200:203], v1 offset:51200
    v_add_f32 v141, v141, v135
    v_mfma_f32_16x16x32_bf16 v[20:23], a[204:207], a[156:159], v[20:23]
    v_exp_f32 v128, v72
    v_mfma_f32_16x16x32_bf16 v[24:27], a[204:207], a[172:175], v[24:27]
    v_cvt_pk_bf16_f32 v103, v134, v135
    v_add_f32 v142, v142, v128
    v_mfma_f32_16x16x32_bf16 v[28:31], a[204:207], a[188:191], v[28:31]
    s_waitcnt lgkmcnt(6)
    v_exp_f32 v129, v73
    v_mfma_f32_16x16x32_bf16 v[32:35], a[208:211], a[128:131], v[112:115]
    ds_read_b128 a[204:207], v1 offset:52224
    v_add_f32 v142, v142, v129
    v_mfma_f32_16x16x32_bf16 v[36:39], a[208:211], a[144:147], v[116:119]
    v_exp_f32 v130, v74
    v_mfma_f32_16x16x32_bf16 v[40:43], a[208:211], a[160:163], v[120:123]
    v_cvt_pk_bf16_f32 v106, v128, v129
    v_add_f32 v142, v142, v130
    v_mfma_f32_16x16x32_bf16 v[44:47], a[208:211], a[176:179], v[124:127]
    s_waitcnt lgkmcnt(6)
    v_exp_f32 v131, v75
    v_mfma_f32_16x16x32_bf16 v[32:35], a[212:215], a[132:135], v[32:35]
    ds_read_b128 a[208:211], v1 offset:53248
    v_add_f32 v142, v142, v131
    v_mfma_f32_16x16x32_bf16 v[36:39], a[212:215], a[148:151], v[36:39]
    v_exp_f32 v132, v76
    v_mfma_f32_16x16x32_bf16 v[40:43], a[212:215], a[164:167], v[40:43]
    v_cvt_pk_bf16_f32 v107, v130, v131
    v_add_f32 v143, v143, v132
    v_mfma_f32_16x16x32_bf16 v[44:47], a[212:215], a[180:183], v[44:47]
    s_waitcnt lgkmcnt(6)
    v_exp_f32 v133, v77
    v_mfma_f32_16x16x32_bf16 v[32:35], a[216:219], a[136:139], v[32:35]
    ds_read_b128 a[212:215], v1 offset:54272
    v_add_f32 v143, v143, v133
    v_mfma_f32_16x16x32_bf16 v[36:39], a[216:219], a[152:155], v[36:39]
    v_exp_f32 v134, v78
    v_max3_f32 v148, v140, v141, v142
    v_mfma_f32_16x16x32_bf16 v[40:43], a[216:219], a[168:171], v[40:43]
    v_cvt_pk_bf16_f32 v110, v132, v133
    v_add_f32 v143, v143, v134
    v_mfma_f32_16x16x32_bf16 v[44:47], a[216:219], a[184:187], v[44:47]
    s_waitcnt lgkmcnt(6)
    v_exp_f32 v135, v79
    v_mfma_f32_16x16x32_bf16 v[32:35], a[220:223], a[140:143], v[32:35]
    ds_read_b128 a[216:219], v1 offset:55296
    v_add_f32 v143, v143, v135
    v_mfma_f32_16x16x32_bf16 v[36:39], a[220:223], a[156:159], v[36:39]
    v_exp_f32 v128, v16
    v_max_f32 v148, v148, v143
    v_mfma_f32_16x16x32_bf16 v[40:43], a[220:223], a[172:175], v[40:43]
    v_cvt_pk_bf16_f32 v111, v134, v135
    v_cmp_lt_f32 vcc, s18, v148
    v_mfma_f32_16x16x32_bf16 v[44:47], a[220:223], a[188:191], v[44:47]
    s_waitcnt lgkmcnt(6)
    s_cbranch_vccnz L_tramp_10
L_back_10:
    v_exp_f32 v129, v17
    v_mfma_f32_16x16x32_bf16 a[0:3], a[192:195], v[96:99], a[0:3]
    ds_read_b128 a[220:223], v1 offset:56320
    v_add_f32 v136, v128, v129
    v_mfma_f32_16x16x32_bf16 a[4:7], a[192:195], v[100:103], a[4:7]
    v_exp_f32 v130, v18
    v_add_f32 v144, v144, v140
    v_mfma_f32_16x16x32_bf16 a[8:11], a[192:195], v[104:107], a[8:11]
    v_cvt_pk_bf16_f32 v80, v128, v129
    v_add_f32 v136, v136, v130
    v_mfma_f32_16x16x32_bf16 a[12:15], a[192:195], v[108:111], a[12:15]
    s_waitcnt lgkmcnt(6)
    v_exp_f32 v131, v19
    v_mfma_f32_16x16x32_bf16 a[16:19], a[196:199], v[96:99], a[16:19]
    ds_read_b128 a[192:195], v1 offset:57344
    v_add_f32 v136, v136, v131
    v_mfma_f32_16x16x32_bf16 a[20:23], a[196:199], v[100:103], a[20:23]
    v_exp_f32 v132, v20
    v_mfma_f32_16x16x32_bf16 a[24:27], a[196:199], v[104:107], a[24:27]
    v_cvt_pk_bf16_f32 v81, v130, v131
    v_add_f32 v145, v145, v141
    v_mfma_f32_16x16x32_bf16 a[28:31], a[196:199], v[108:111], a[28:31]
    s_waitcnt lgkmcnt(6)
    v_exp_f32 v133, v21
    v_mfma_f32_16x16x32_bf16 a[32:35], a[200:203], v[96:99], a[32:35]
    ds_read_b128 a[196:199], v1 offset:58368
    v_add_f32 v137, v132, v133
    v_mfma_f32_16x16x32_bf16 a[36:39], a[200:203], v[100:103], a[36:39]
    v_exp_f32 v134, v22
    v_mfma_f32_16x16x32_bf16 a[40:43], a[200:203], v[104:107], a[40:43]
    v_cvt_pk_bf16_f32 v84, v132, v133
    v_add_f32 v137, v137, v134
    v_mfma_f32_16x16x32_bf16 a[44:47], a[200:203], v[108:111], a[44:47]
    s_waitcnt lgkmcnt(6)
    v_exp_f32 v135, v23
    v_mfma_f32_16x16x32_bf16 a[48:51], a[204:207], v[96:99], a[48:51]
    ds_read_b128 a[200:203], v1 offset:59392
    v_add_f32 v137, v137, v135
    v_mfma_f32_16x16x32_bf16 a[52:55], a[204:207], v[100:103], a[52:55]
    v_exp_f32 v128, v24
    v_mfma_f32_16x16x32_bf16 a[56:59], a[204:207], v[104:107], a[56:59]
    v_cvt_pk_bf16_f32 v85, v134, v135
    v_add_f32 v146, v146, v142
    v_mfma_f32_16x16x32_bf16 a[60:63], a[204:207], v[108:111], a[60:63]
    s_waitcnt lgkmcnt(6)
    v_exp_f32 v129, v25
    v_mfma_f32_16x16x32_bf16 a[64:67], a[208:211], v[96:99], a[64:67]
    ds_read_b128 a[204:207], v1 offset:60416
    v_add_f32 v138, v128, v129
    v_mfma_f32_16x16x32_bf16 a[68:71], a[208:211], v[100:103], a[68:71]
    v_exp_f32 v130, v26
    v_mfma_f32_16x16x32_bf16 a[72:75], a[208:211], v[104:107], a[72:75]
    s_waitcnt vmcnt(8)
    s_barrier
    v_cvt_pk_bf16_f32 v88, v128, v129
    v_add_f32 v138, v138, v130
    v_mfma_f32_16x16x32_bf16 a[76:79], a[208:211], v[108:111], a[76:79]
    s_waitcnt lgkmcnt(6)
    v_exp_f32 v131, v27
    v_mfma_f32_16x16x32_bf16 a[80:83], a[212:215], v[96:99], a[80:83]
    ds_read_b128 a[208:211], v1 offset:61440
    v_add_f32 v138, v138, v131
    v_mfma_f32_16x16x32_bf16 a[84:87], a[212:215], v[100:103], a[84:87]
    v_exp_f32 v132, v28
    v_mfma_f32_16x16x32_bf16 a[88:91], a[212:215], v[104:107], a[88:91]
    v_cvt_pk_bf16_f32 v89, v130, v131
    v_add_f32 v147, v147, v143
    v_mfma_f32_16x16x32_bf16 a[92:95], a[212:215], v[108:111], a[92:95]
    s_waitcnt lgkmcnt(6)
    v_exp_f32 v133, v29
    v_mfma_f32_16x16x32_bf16 a[96:99], a[216:219], v[96:99], a[96:99]
    ds_read_b128 a[212:215], v1 offset:62464
    v_add_f32 v139, v132, v133
    v_mfma_f32_16x16x32_bf16 a[100:103], a[216:219], v[100:103], a[100:103]
    v_exp_f32 v134, v30
    v_mfma_f32_16x16x32_bf16 a[104:107], a[216:219], v[104:107], a[104:107]
    v_cvt_pk_bf16_f32 v92, v132, v133
    v_add_f32 v139, v139, v134
    v_mfma_f32_16x16x32_bf16 a[108:111], a[216:219], v[108:111], a[108:111]
    s_waitcnt lgkmcnt(6)
    v_exp_f32 v135, v31
    v_mfma_f32_16x16x32_bf16 a[112:115], a[220:223], v[96:99], a[112:115]
    ds_read_b128 a[216:219], v1 offset:63488
    v_add_f32 v139, v139, v135
    v_mfma_f32_16x16x32_bf16 a[116:119], a[220:223], v[100:103], a[116:119]
    v_exp_f32 v128, v32
    v_mfma_f32_16x16x32_bf16 a[120:123], a[220:223], v[104:107], a[120:123]
    v_cvt_pk_bf16_f32 v93, v134, v135
    v_add_f32 v136, v136, v128
    v_mfma_f32_16x16x32_bf16 a[124:127], a[220:223], v[108:111], a[124:127]
    s_waitcnt lgkmcnt(6)
    v_exp_f32 v129, v33
    v_mfma_f32_16x16x32_bf16 v[48:51], a[192:195], a[128:131], v[112:115]
    ds_read_b128 a[220:223], v1 offset:64512
    v_add_f32 v136, v136, v129
    v_mfma_f32_16x16x32_bf16 v[52:55], a[192:195], a[144:147], v[116:119]
    v_exp_f32 v130, v34
    v_mfma_f32_16x16x32_bf16 v[56:59], a[192:195], a[160:163], v[120:123]
    v_cvt_pk_bf16_f32 v82, v128, v129
    v_add_f32 v136, v136, v130
    v_mfma_f32_16x16x32_bf16 v[60:63], a[192:195], a[176:179], v[124:127]
    s_waitcnt lgkmcnt(6)
    v_exp_f32 v131, v35
    v_mfma_f32_16x16x32_bf16 v[48:51], a[196:199], a[132:135], v[48:51]
    ds_read_b128 a[192:195], v2 offset:0
    v_add_f32 v136, v136, v131
    v_mfma_f32_16x16x32_bf16 v[52:55], a[196:199], a[148:151], v[52:55]
    v_exp_f32 v132, v36
    v_mfma_f32_16x16x32_bf16 v[56:59], a[196:199], a[164:167], v[56:59]
    v_cvt_pk_bf16_f32 v83, v130, v131
    v_add_f32 v137, v137, v132
    v_mfma_f32_16x16x32_bf16 v[60:63], a[196:199], a[180:183], v[60:63]
    s_waitcnt lgkmcnt(6)
    v_exp_f32 v133, v37
    v_mfma_f32_16x16x32_bf16 v[48:51], a[200:203], a[136:139], v[48:51]
    ds_read_b128 a[196:199], v2 offset:1024
    v_add_f32 v137, v137, v133
    v_mfma_f32_16x16x32_bf16 v[52:55], a[200:203], a[152:155], v[52:55]
    v_exp_f32 v134, v38
    v_mfma_f32_16x16x32_bf16 v[56:59], a[200:203], a[168:171], v[56:59]
    v_cvt_pk_bf16_f32 v86, v132, v133
    v_add_f32 v137, v137, v134
    v_mfma_f32_16x16x32_bf16 v[60:63], a[200:203], a[184:187], v[60:63]
    s_waitcnt lgkmcnt(6)
    v_exp_f32 v135, v39
    v_mfma_f32_16x16x32_bf16 v[48:51], a[204:207], a[140:143], v[48:51]
    ds_read_b128 a[200:203], v2 offset:2048
    v_add_f32 v137, v137, v135
    v_mfma_f32_16x16x32_bf16 v[52:55], a[204:207], a[156:159], v[52:55]
    v_exp_f32 v128, v40
    v_mfma_f32_16x16x32_bf16 v[56:59], a[204:207], a[172:175], v[56:59]
    v_cvt_pk_bf16_f32 v87, v134, v135
    v_add_f32 v138, v138, v128
    v_mfma_f32_16x16x32_bf16 v[60:63], a[204:207], a[188:191], v[60:63]
    s_waitcnt lgkmcnt(6)
    v_exp_f32 v129, v41
    v_mfma_f32_16x16x32_bf16 v[64:67], a[208:211], a[128:131], v[112:115]
    ds_read_b128 a[204:207], v2 offset:3072
    v_add_f32 v138, v138, v129
    v_mfma_f32_16x16x32_bf16 v[68:71], a[208:211], a[144:147], v[116:119]
    v_exp_f32 v130, v42
    v_mfma_f32_16x16x32_bf16 v[72:75], a[208:211], a[160:163], v[120:123]
    v_cvt_pk_bf16_f32 v90, v128, v129
    v_add_f32 v138, v138, v130
    v_mfma_f32_16x16x32_bf16 v[76:79], a[208:211], a[176:179], v[124:127]
    s_waitcnt lgkmcnt(6)
    v_exp_f32 v131, v43
    v_mfma_f32_16x16x32_bf16 v[64:67], a[212:215], a[132:135], v[64:67]
    ds_read_b128 a[208:211], v2 offset:4096
    v_add_f32 v138, v138, v131
    v_mfma_f32_16x16x32_bf16 v[68:71], a[212:215], a[148:151], v[68:71]
    v_exp_f32 v132, v44
    v_mfma_f32_16x16x32_bf16 v[72:75], a[212:215], a[164:167], v[72:75]
    v_cvt_pk_bf16_f32 v91, v130, v131
    v_add_f32 v139, v139, v132
    v_mfma_f32_16x16x32_bf16 v[76:79], a[212:215], a[180:183], v[76:79]
    s_waitcnt lgkmcnt(6)
    v_exp_f32 v133, v45
    v_mfma_f32_16x16x32_bf16 v[64:67], a[216:219], a[136:139], v[64:67]
    ds_read_b128 a[212:215], v2 offset:5120
    v_add_f32 v139, v139, v133
    v_mfma_f32_16x16x32_bf16 v[68:71], a[216:219], a[152:155], v[68:71]
    v_exp_f32 v134, v46
    v_max3_f32 v148, v136, v137, v138
    v_mfma_f32_16x16x32_bf16 v[72:75], a[216:219], a[168:171], v[72:75]
    v_cvt_pk_bf16_f32 v94, v132, v133
    v_add_f32 v139, v139, v134
    v_mfma_f32_16x16x32_bf16 v[76:79], a[216:219], a[184:187], v[76:79]
    s_waitcnt lgkmcnt(6)
    v_exp_f32 v135, v47
    v_mfma_f32_16x16x32_bf16 v[64:67], a[220:223], a[140:143], v[64:67]
    ds_read_b128 a[216:219], v2 offset:6144
    v_add_f32 v139, v139, v135
    v_mfma_f32_16x16x32_bf16 v[68:71], a[220:223], a[156:159], v[68:71]
    v_exp_f32 v128, v48
    v_max_f32 v148, v148, v139
    v_mfma_f32_16x16x32_bf16 v[72:75], a[220:223], a[172:175], v[72:75]
    v_cvt_pk_bf16_f32 v95, v134, v135
    v_cmp_lt_f32 vcc, s18, v148
    v_mfma_f32_16x16x32_bf16 v[76:79], a[220:223], a[188:191], v[76:79]
    s_waitcnt lgkmcnt(6)
    s_cbranch_vccnz L_tramp_11
L_back_11:
    v_exp_f32 v129, v49
    v_mfma_f32_16x16x32_bf16 a[0:3], a[192:195], v[80:83], a[0:3]
    ds_read_b128 a[220:223], v2 offset:7168
    v_add_f32 v140, v128, v129
    v_mfma_f32_16x16x32_bf16 a[4:7], a[192:195], v[84:87], a[4:7]
    v_exp_f32 v130, v50
    v_add_f32 v144, v144, v136
    v_mfma_f32_16x16x32_bf16 a[8:11], a[192:195], v[88:91], a[8:11]
    v_cvt_pk_bf16_f32 v96, v128, v129
    v_add_f32 v140, v140, v130
    v_mfma_f32_16x16x32_bf16 a[12:15], a[192:195], v[92:95], a[12:15]
    s_waitcnt lgkmcnt(6)
    v_exp_f32 v131, v51
    v_mfma_f32_16x16x32_bf16 a[16:19], a[196:199], v[80:83], a[16:19]
    ds_read_b128 a[192:195], v2 offset:8192
    v_add_f32 v140, v140, v131
    v_mfma_f32_16x16x32_bf16 a[20:23], a[196:199], v[84:87], a[20:23]
    v_exp_f32 v132, v52
    v_mfma_f32_16x16x32_bf16 a[24:27], a[196:199], v[88:91], a[24:27]
    v_cvt_pk_bf16_f32 v97, v130, v131
    v_add_f32 v145, v145, v137
    v_mfma_f32_16x16x32_bf16 a[28:31], a[196:199], v[92:95], a[28:31]
    s_waitcnt lgkmcnt(6)
    v_exp_f32 v133, v53
    v_mfma_f32_16x16x32_bf16 a[32:35], a[200:203], v[80:83], a[32:35]
    ds_read_b128 a[196:199], v2 offset:9216
    v_add_f32 v141, v132, v133
    v_mfma_f32_16x16x32_bf16 a[36:39], a[200:203], v[84:87], a[36:39]
    v_exp_f32 v134, v54
    v_mfma_f32_16x16x32_bf16 a[40:43], a[200:203], v[88:91], a[40:43]
    v_cvt_pk_bf16_f32 v100, v132, v133
    v_add_f32 v141, v141, v134
    v_mfma_f32_16x16x32_bf16 a[44:47], a[200:203], v[92:95], a[44:47]
    s_waitcnt lgkmcnt(6)
    v_exp_f32 v135, v55
    v_mfma_f32_16x16x32_bf16 a[48:51], a[204:207], v[80:83], a[48:51]
    ds_read_b128 a[200:203], v2 offset:10240
    v_add_f32 v141, v141, v135
    v_mfma_f32_16x16x32_bf16 a[52:55], a[204:207], v[84:87], a[52:55]
    v_exp_f32 v128, v56
    v_mfma_f32_16x16x32_bf16 a[56:59], a[204:207], v[88:91], a[56:59]
    v_cvt_pk_bf16_f32 v101, v134, v135
    v_add_f32 v146, v146, v138
    v_mfma_f32_16x16x32_bf16 a[60:63], a[204:207], v[92:95], a[60:63]
    s_waitcnt lgkmcnt(6)
    v_exp_f32 v129, v57
    v_mfma_f32_16x16x32_bf16 a[64:67], a[208:211], v[80:83], a[64:67]
    ds_read_b128 a[204:207], v2 offset:11264
    v_add_f32 v142, v128, v129
    v_mfma_f32_16x16x32_bf16 a[68:71], a[208:211], v[84:87], a[68:71]
    v_exp_f32 v130, v58
    v_mfma_f32_16x16x32_bf16 a[72:75], a[208:211], v[88:91], a[72:75]
    v_cvt_pk_bf16_f32 v104, v128, v129
    v_add_f32 v142, v142, v130
    v_mfma_f32_16x16x32_bf16 a[76:79], a[208:211], v[92:95], a[76:79]
    s_waitcnt lgkmcnt(6)
    v_exp_f32 v131, v59
    v_mfma_f32_16x16x32_bf16 a[80:83], a[212:215], v[80:83], a[80:83]
    ds_read_b128 a[208:211], v2 offset:12288
    v_add_f32 v142, v142, v131
    v_mfma_f32_16x16x32_bf16 a[84:87], a[212:215], v[84:87], a[84:87]
    v_exp_f32 v132, v60
    v_mfma_f32_16x16x32_bf16 a[88:91], a[212:215], v[88:91], a[88:91]
    v_cvt_pk_bf16_f32 v105, v130, v131
    v_add_f32 v147, v147, v139
    v_mfma_f32_16x16x32_bf16 a[92:95], a[212:215], v[92:95], a[92:95]
    s_waitcnt lgkmcnt(6)
    v_exp_f32 v133, v61
    v_mfma_f32_16x16x32_bf16 a[96:99], a[216:219], v[80:83], a[96:99]
    ds_read_b128 a[212:215], v2 offset:13312
    v_add_f32 v143, v132, v133
    v_mfma_f32_16x16x32_bf16 a[100:103], a[216:219], v[84:87], a[100:103]
    v_exp_f32 v134, v62
    v_mfma_f32_16x16x32_bf16 a[104:107], a[216:219], v[88:91], a[104:107]
    v_cvt_pk_bf16_f32 v108, v132, v133
    v_add_f32 v143, v143, v134
    v_mfma_f32_16x16x32_bf16 a[108:111], a[216:219], v[92:95], a[108:111]
    s_waitcnt lgkmcnt(6)
    v_exp_f32 v135, v63
    v_mfma_f32_16x16x32_bf16 a[112:115], a[220:223], v[80:83], a[112:115]
    ds_read_b128 a[216:219], v2 offset:14336
    v_add_f32 v143, v143, v135
    v_mfma_f32_16x16x32_bf16 a[116:119], a[220:223], v[84:87], a[116:119]
    v_exp_f32 v128, v64
    v_mfma_f32_16x16x32_bf16 a[120:123], a[220:223], v[88:91], a[120:123]
    v_cvt_pk_bf16_f32 v109, v134, v135
    v_add_f32 v140, v140, v128
    v_mfma_f32_16x16x32_bf16 a[124:127], a[220:223], v[92:95], a[124:127]
    s_waitcnt lgkmcnt(6)
    v_exp_f32 v129, v65
    v_mfma_f32_16x16x32_bf16 v[16:19], a[192:195], a[128:131], v[112:115]
    ds_read_b128 a[220:223], v2 offset:15360
    v_add_f32 v140, v140, v129
    v_mfma_f32_16x16x32_bf16 v[20:23], a[192:195], a[144:147], v[116:119]
    v_exp_f32 v130, v66
    v_mfma_f32_16x16x32_bf16 v[24:27], a[192:195], a[160:163], v[120:123]
    v_cvt_pk_bf16_f32 v98, v128, v129
    v_add_f32 v140, v140, v130
    v_mfma_f32_16x16x32_bf16 v[28:31], a[192:195], a[176:179], v[124:127]
    s_waitcnt lgkmcnt(6)
    v_exp_f32 v131, v67
    v_mfma_f32_16x16x32_bf16 v[16:19], a[196:199], a[132:135], v[16:19]
    ds_read_b128 a[192:195], v2 offset:16384
    v_add_f32 v140, v140, v131
    v_mfma_f32_16x16x32_bf16 v[20:23], a[196:199], a[148:151], v[20:23]
    v_exp_f32 v132, v68
    v_mfma_f32_16x16x32_bf16 v[24:27], a[196:199], a[164:167], v[24:27]
    v_cvt_pk_bf16_f32 v99, v130, v131
    v_add_f32 v141, v141, v132
    v_mfma_f32_16x16x32_bf16 v[28:31], a[196:199], a[180:183], v[28:31]
    s_waitcnt lgkmcnt(6)
    v_exp_f32 v133, v69
    v_mfma_f32_16x16x32_bf16 v[16:19], a[200:203], a[136:139], v[16:19]
    ds_read_b128 a[196:199], v2 offset:17408
    v_add_f32 v141, v141, v133
    v_mfma_f32_16x16x32_bf16 v[20:23], a[200:203], a[152:155], v[20:23]
    v_exp_f32 v134, v70
    v_mfma_f32_16x16x32_bf16 v[24:27], a[200:203], a[168:171], v[24:27]
    v_cvt_pk_bf16_f32 v102, v132, v133
    v_add_f32 v141, v141, v134
    v_mfma_f32_16x16x32_bf16 v[28:31], a[200:203], a[184:187], v[28:31]
    s_waitcnt lgkmcnt(6)
    v_exp_f32 v135, v71
    v_mfma_f32_16x16x32_bf16 v[16:19], a[204:207], a[140:143], v[16:19]
    ds_read_b128 a[200:203], v2 offset:18432
    v_add_f32 v141, v141, v135
    v_mfma_f32_16x16x32_bf16 v[20:23], a[204:207], a[156:159], v[20:23]
    v_exp_f32 v128, v72
    v_mfma_f32_16x16x32_bf16 v[24:27], a[204:207], a[172:175], v[24:27]
    v_cvt_pk_bf16_f32 v103, v134, v135
    v_add_f32 v142, v142, v128
    v_mfma_f32_16x16x32_bf16 v[28:31], a[204:207], a[188:191], v[28:31]
    s_waitcnt lgkmcnt(6)
    v_exp_f32 v129, v73
    v_mfma_f32_16x16x32_bf16 v[32:35], a[208:211], a[128:131], v[112:115]
    ds_read_b128 a[204:207], v2 offset:19456
    v_add_f32 v142, v142, v129
    v_mfma_f32_16x16x32_bf16 v[36:39], a[208:211], a[144:147], v[116:119]
    v_exp_f32 v130, v74
    v_mfma_f32_16x16x32_bf16 v[40:43], a[208:211], a[160:163], v[120:123]
    v_cvt_pk_bf16_f32 v106, v128, v129
    v_add_f32 v142, v142, v130
    v_mfma_f32_16x16x32_bf16 v[44:47], a[208:211], a[176:179], v[124:127]
    s_waitcnt lgkmcnt(6)
    v_exp_f32 v131, v75
    v_mfma_f32_16x16x32_bf16 v[32:35], a[212:215], a[132:135], v[32:35]
    ds_read_b128 a[208:211], v2 offset:20480
    v_add_f32 v142, v142, v131
    v_mfma_f32_16x16x32_bf16 v[36:39], a[212:215], a[148:151], v[36:39]
    v_exp_f32 v132, v76
    v_mfma_f32_16x16x32_bf16 v[40:43], a[212:215], a[164:167], v[40:43]
    v_cvt_pk_bf16_f32 v107, v130, v131
    v_add_f32 v143, v143, v132
    v_mfma_f32_16x16x32_bf16 v[44:47], a[212:215], a[180:183], v[44:47]
    s_waitcnt lgkmcnt(6)
    v_exp_f32 v133, v77
    v_mfma_f32_16x16x32_bf16 v[32:35], a[216:219], a[136:139], v[32:35]
    ds_read_b128 a[212:215], v2 offset:21504
    v_add_f32 v143, v143, v133
    v_mfma_f32_16x16x32_bf16 v[36:39], a[216:219], a[152:155], v[36:39]
    v_exp_f32 v134, v78
    v_max3_f32 v148, v140, v141, v142
    v_mfma_f32_16x16x32_bf16 v[40:43], a[216:219], a[168:171], v[40:43]
    v_cvt_pk_bf16_f32 v110, v132, v133
    v_add_f32 v143, v143, v134
    v_mfma_f32_16x16x32_bf16 v[44:47], a[216:219], a[184:187], v[44:47]
    s_waitcnt lgkmcnt(6)
    v_exp_f32 v135, v79
    v_mfma_f32_16x16x32_bf16 v[32:35], a[220:223], a[140:143], v[32:35]
    ds_read_b128 a[216:219], v2 offset:22528
    v_add_f32 v143, v143, v135
    v_mfma_f32_16x16x32_bf16 v[36:39], a[220:223], a[156:159], v[36:39]
    v_exp_f32 v128, v16
    v_max_f32 v148, v148, v143
    v_mfma_f32_16x16x32_bf16 v[40:43], a[220:223], a[172:175], v[40:43]
    v_cvt_pk_bf16_f32 v111, v134, v135
    v_cmp_lt_f32 vcc, s18, v148
    v_mfma_f32_16x16x32_bf16 v[44:47], a[220:223], a[188:191], v[44:47]
    s_waitcnt lgkmcnt(6)
    s_cbranch_vccnz L_tramp_12
L_back_12:
    v_exp_f32 v129, v17
    v_mfma_f32_16x16x32_bf16 a[0:3], a[192:195], v[96:99], a[0:3]
    ds_read_b128 a[220:223], v2 offset:23552
    v_add_f32 v136, v128, v129
    v_mfma_f32_16x16x32_bf16 a[4:7], a[192:195], v[100:103], a[4:7]
    v_exp_f32 v130, v18
    v_add_f32 v144, v144, v140
    v_mfma_f32_16x16x32_bf16 a[8:11], a[192:195], v[104:107], a[8:11]
    v_cvt_pk_bf16_f32 v80, v128, v129
    v_add_f32 v136, v136, v130
    v_mfma_f32_16x16x32_bf16 a[12:15], a[192:195], v[108:111], a[12:15]
    s_waitcnt lgkmcnt(6)
    v_exp_f32 v131, v19
    v_mfma_f32_16x16x32_bf16 a[16:19], a[196:199], v[96:99], a[16:19]
    ds_read_b128 a[192:195], v2 offset:24576
    v_add_f32 v136, v136, v131
    v_mfma_f32_16x16x32_bf16 a[20:23], a[196:199], v[100:103], a[20:23]
    v_exp_f32 v132, v20
    v_mfma_f32_16x16x32_bf16 a[24:27], a[196:199], v[104:107], a[24:27]
    v_cvt_pk_bf16_f32 v81, v130, v131
    v_add_f32 v145, v145, v141
    v_mfma_f32_16x16x32_bf16 a[28:31], a[196:199], v[108:111], a[28:31]
    s_waitcnt lgkmcnt(6)
    v_exp_f32 v133, v21
    v_mfma_f32_16x16x32_bf16 a[32:35], a[200:203], v[96:99], a[32:35]
    ds_read_b128 a[196:199], v2 offset:25600
    v_add_f32 v137, v132, v133
    v_mfma_f32_16x16x32_bf16 a[36:39], a[200:203], v[100:103], a[36:39]
    v_exp_f32 v134, v22
    v_mfma_f32_16x16x32_bf16 a[40:43], a[200:203], v[104:107], a[40:43]
    v_cvt_pk_bf16_f32 v84, v132, v133
    v_add_f32 v137, v137, v134
    v_mfma_f32_16x16x32_bf16 a[44:47], a[200:203], v[108:111], a[44:47]
    s_waitcnt lgkmcnt(6)
    v_exp_f32 v135, v23
    v_mfma_f32_16x16x32_bf16 a[48:51], a[204:207], v[96:99], a[48:51]
    ds_read_b128 a[200:203], v2 offset:26624
    v_add_f32 v137, v137, v135
    v_mfma_f32_16x16x32_bf16 a[52:55], a[204:207], v[100:103], a[52:55]
    v_exp_f32 v128, v24
    v_mfma_f32_16x16x32_bf16 a[56:59], a[204:207], v[104:107], a[56:59]
    v_cvt_pk_bf16_f32 v85, v134, v135
    v_add_f32 v146, v146, v142
    v_mfma_f32_16x16x32_bf16 a[60:63], a[204:207], v[108:111], a[60:63]
    s_waitcnt lgkmcnt(6)
    v_exp_f32 v129, v25
    v_mfma_f32_16x16x32_bf16 a[64:67], a[208:211], v[96:99], a[64:67]
    ds_read_b128 a[204:207], v2 offset:27648
    v_add_f32 v138, v128, v129
    v_mfma_f32_16x16x32_bf16 a[68:71], a[208:211], v[100:103], a[68:71]
    v_exp_f32 v130, v26
    v_mfma_f32_16x16x32_bf16 a[72:75], a[208:211], v[104:107], a[72:75]
    s_waitcnt vmcnt(0)
    s_barrier
    v_cvt_pk_bf16_f32 v88, v128, v129
    v_add_f32 v138, v138, v130
    v_mfma_f32_16x16x32_bf16 a[76:79], a[208:211], v[108:111], a[76:79]
    s_waitcnt lgkmcnt(6)
    v_exp_f32 v131, v27
    v_mfma_f32_16x16x32_bf16 a[80:83], a[212:215], v[96:99], a[80:83]
    ds_read_b128 a[208:211], v2 offset:28672
    v_add_f32 v138, v138, v131
    v_mfma_f32_16x16x32_bf16 a[84:87], a[212:215], v[100:103], a[84:87]
    v_exp_f32 v132, v28
    v_mfma_f32_16x16x32_bf16 a[88:91], a[212:215], v[104:107], a[88:91]
    v_cvt_pk_bf16_f32 v89, v130, v131
    v_add_f32 v147, v147, v143
    v_mfma_f32_16x16x32_bf16 a[92:95], a[212:215], v[108:111], a[92:95]
    s_waitcnt lgkmcnt(6)
    v_exp_f32 v133, v29
    v_mfma_f32_16x16x32_bf16 a[96:99], a[216:219], v[96:99], a[96:99]
    ds_read_b128 a[212:215], v2 offset:29696
    v_add_f32 v139, v132, v133
    v_mfma_f32_16x16x32_bf16 a[100:103], a[216:219], v[100:103], a[100:103]
    v_exp_f32 v134, v30
    v_mfma_f32_16x16x32_bf16 a[104:107], a[216:219], v[104:107], a[104:107]
    v_cvt_pk_bf16_f32 v92, v132, v133
    v_add_f32 v139, v139, v134
    v_mfma_f32_16x16x32_bf16 a[108:111], a[216:219], v[108:111], a[108:111]
    s_waitcnt lgkmcnt(6)
    v_exp_f32 v135, v31
    v_mfma_f32_16x16x32_bf16 a[112:115], a[220:223], v[96:99], a[112:115]
    ds_read_b128 a[216:219], v2 offset:30720
    v_add_f32 v139, v139, v135
    v_mfma_f32_16x16x32_bf16 a[116:119], a[220:223], v[100:103], a[116:119]
    v_exp_f32 v128, v32
    v_mfma_f32_16x16x32_bf16 a[120:123], a[220:223], v[104:107], a[120:123]
    v_cvt_pk_bf16_f32 v93, v134, v135
    v_add_f32 v136, v136, v128
    v_mfma_f32_16x16x32_bf16 a[124:127], a[220:223], v[108:111], a[124:127]
    s_waitcnt lgkmcnt(6)
    v_exp_f32 v129, v33
    v_mfma_f32_16x16x32_bf16 v[48:51], a[192:195], a[128:131], v[112:115]
    ds_read_b128 a[220:223], v2 offset:31744
    v_add_f32 v136, v136, v129
    v_mfma_f32_16x16x32_bf16 v[52:55], a[192:195], a[144:147], v[116:119]
    v_exp_f32 v130, v34
    v_mfma_f32_16x16x32_bf16 v[56:59], a[192:195], a[160:163], v[120:123]
    v_cvt_pk_bf16_f32 v82, v128, v129
    v_add_f32 v136, v136, v130
    v_mfma_f32_16x16x32_bf16 v[60:63], a[192:195], a[176:179], v[124:127]
    s_waitcnt lgkmcnt(6)
    v_exp_f32 v131, v35
    v_mfma_f32_16x16x32_bf16 v[48:51], a[196:199], a[132:135], v[48:51]
    ds_read_b128 a[192:195], v2 offset:32768
    v_add_f32 v136, v136, v131
    v_mfma_f32_16x16x32_bf16 v[52:55], a[196:199], a[148:151], v[52:55]
    v_exp_f32 v132, v36
    v_mfma_f32_16x16x32_bf16 v[56:59], a[196:199], a[164:167], v[56:59]
    v_cvt_pk_bf16_f32 v83, v130, v131
    v_add_f32 v137, v137, v132
    v_mfma_f32_16x16x32_bf16 v[60:63], a[196:199], a[180:183], v[60:63]
    s_waitcnt lgkmcnt(6)
    v_exp_f32 v133, v37
    v_mfma_f32_16x16x32_bf16 v[48:51], a[200:203], a[136:139], v[48:51]
    ds_read_b128 a[196:199], v2 offset:33792
    v_add_f32 v137, v137, v133
    v_mfma_f32_16x16x32_bf16 v[52:55], a[200:203], a[152:155], v[52:55]
    v_exp_f32 v134, v38
    v_mfma_f32_16x16x32_bf16 v[56:59], a[200:203], a[168:171], v[56:59]
    v_cvt_pk_bf16_f32 v86, v132, v133
    v_add_f32 v137, v137, v134
    v_mfma_f32_16x16x32_bf16 v[60:63], a[200:203], a[184:187], v[60:63]
    s_waitcnt lgkmcnt(6)
    v_exp_f32 v135, v39
    v_mfma_f32_16x16x32_bf16 v[48:51], a[204:207], a[140:143], v[48:51]
    ds_read_b128 a[200:203], v2 offset:34816
    v_add_f32 v137, v137, v135
    v_mfma_f32_16x16x32_bf16 v[52:55], a[204:207], a[156:159], v[52:55]
    v_exp_f32 v128, v40
    v_mfma_f32_16x16x32_bf16 v[56:59], a[204:207], a[172:175], v[56:59]
    v_cvt_pk_bf16_f32 v87, v134, v135
    v_add_f32 v138, v138, v128
    v_mfma_f32_16x16x32_bf16 v[60:63], a[204:207], a[188:191], v[60:63]
    s_waitcnt lgkmcnt(6)
    v_exp_f32 v129, v41
    v_mfma_f32_16x16x32_bf16 v[64:67], a[208:211], a[128:131], v[112:115]
    ds_read_b128 a[204:207], v2 offset:35840
    v_add_f32 v138, v138, v129
    v_mfma_f32_16x16x32_bf16 v[68:71], a[208:211], a[144:147], v[116:119]
    v_exp_f32 v130, v42
    v_mfma_f32_16x16x32_bf16 v[72:75], a[208:211], a[160:163], v[120:123]
    v_cvt_pk_bf16_f32 v90, v128, v129
    v_add_f32 v138, v138, v130
    v_mfma_f32_16x16x32_bf16 v[76:79], a[208:211], a[176:179], v[124:127]
    s_waitcnt lgkmcnt(6)
    v_exp_f32 v131, v43
    v_mfma_f32_16x16x32_bf16 v[64:67], a[212:215], a[132:135], v[64:67]
    ds_read_b128 a[208:211], v2 offset:36864
    v_add_f32 v138, v138, v131
    v_mfma_f32_16x16x32_bf16 v[68:71], a[212:215], a[148:151], v[68:71]
    v_exp_f32 v132, v44
    v_mfma_f32_16x16x32_bf16 v[72:75], a[212:215], a[164:167], v[72:75]
    v_cvt_pk_bf16_f32 v91, v130, v131
    v_add_f32 v139, v139, v132
    v_mfma_f32_16x16x32_bf16 v[76:79], a[212:215], a[180:183], v[76:79]
    s_waitcnt lgkmcnt(6)
    v_exp_f32 v133, v45
    v_mfma_f32_16x16x32_bf16 v[64:67], a[216:219], a[136:139], v[64:67]
    ds_read_b128 a[212:215], v2 offset:37888
    v_add_f32 v139, v139, v133
    v_mfma_f32_16x16x32_bf16 v[68:71], a[216:219], a[152:155], v[68:71]
    v_exp_f32 v134, v46
    v_max3_f32 v148, v136, v137, v138
    v_mfma_f32_16x16x32_bf16 v[72:75], a[216:219], a[168:171], v[72:75]
    v_cvt_pk_bf16_f32 v94, v132, v133
    v_add_f32 v139, v139, v134
    v_mfma_f32_16x16x32_bf16 v[76:79], a[216:219], a[184:187], v[76:79]
    s_waitcnt lgkmcnt(6)
    v_exp_f32 v135, v47
    v_mfma_f32_16x16x32_bf16 v[64:67], a[220:223], a[140:143], v[64:67]
    ds_read_b128 a[216:219], v2 offset:38912
    v_add_f32 v139, v139, v135
    v_mfma_f32_16x16x32_bf16 v[68:71], a[220:223], a[156:159], v[68:71]
    v_exp_f32 v128, v48
    v_max_f32 v148, v148, v139
    v_mfma_f32_16x16x32_bf16 v[72:75], a[220:223], a[172:175], v[72:75]
    v_cvt_pk_bf16_f32 v95, v134, v135
    v_cmp_lt_f32 vcc, s18, v148
    v_mfma_f32_16x16x32_bf16 v[76:79], a[220:223], a[188:191], v[76:79]
    s_waitcnt lgkmcnt(6)
    s_cbranch_vccnz L_tramp_13
L_back_13:
    v_exp_f32 v129, v49
    v_mfma_f32_16x16x32_bf16 a[0:3], a[192:195], v[80:83], a[0:3]
    ds_read_b128 a[220:223], v2 offset:39936
    v_add_f32 v140, v128, v129
    v_mfma_f32_16x16x32_bf16 a[4:7], a[192:195], v[84:87], a[4:7]
    v_exp_f32 v130, v50
    v_add_f32 v144, v144, v136
    v_mfma_f32_16x16x32_bf16 a[8:11], a[192:195], v[88:91], a[8:11]
    v_cvt_pk_bf16_f32 v96, v128, v129
    v_add_f32 v140, v140, v130
    v_mfma_f32_16x16x32_bf16 a[12:15], a[192:195], v[92:95], a[12:15]
    s_waitcnt lgkmcnt(6)
    v_exp_f32 v131, v51
    v_mfma_f32_16x16x32_bf16 a[16:19], a[196:199], v[80:83], a[16:19]
    v_add_f32 v140, v140, v131
    v_mfma_f32_16x16x32_bf16 a[20:23], a[196:199], v[84:87], a[20:23]
    v_exp_f32 v132, v52
    v_mfma_f32_16x16x32_bf16 a[24:27], a[196:199], v[88:91], a[24:27]
    v_cvt_pk_bf16_f32 v97, v130, v131
    v_add_f32 v145, v145, v137
    v_mfma_f32_16x16x32_bf16 a[28:31], a[196:199], v[92:95], a[28:31]
    s_waitcnt lgkmcnt(5)
    v_exp_f32 v133, v53
    v_mfma_f32_16x16x32_bf16 a[32:35], a[200:203], v[80:83], a[32:35]
    v_add_f32 v141, v132, v133
    v_mfma_f32_16x16x32_bf16 a[36:39], a[200:203], v[84:87], a[36:39]
    v_exp_f32 v134, v54
    v_mfma_f32_16x16x32_bf16 a[40:43], a[200:203], v[88:91], a[40:43]
    v_cvt_pk_bf16_f32 v100, v132, v133
    v_add_f32 v141, v141, v134
    v_mfma_f32_16x16x32_bf16 a[44:47], a[200:203], v[92:95], a[44:47]
    s_waitcnt lgkmcnt(4)
    v_exp_f32 v135, v55
    v_mfma_f32_16x16x32_bf16 a[48:51], a[204:207], v[80:83], a[48:51]
    v_add_f32 v141, v141, v135
    v_mfma_f32_16x16x32_bf16 a[52:55], a[204:207], v[84:87], a[52:55]
    v_exp_f32 v128, v56
    v_mfma_f32_16x16x32_bf16 a[56:59], a[204:207], v[88:91], a[56:59]
    v_cvt_pk_bf16_f32 v101, v134, v135
    v_add_f32 v146, v146, v138
    v_mfma_f32_16x16x32_bf16 a[60:63], a[204:207], v[92:95], a[60:63]
    s_waitcnt lgkmcnt(3)
    v_exp_f32 v129, v57
    v_mfma_f32_16x16x32_bf16 a[64:67], a[208:211], v[80:83], a[64:67]
    v_add_f32 v142, v128, v129
    v_mfma_f32_16x16x32_bf16 a[68:71], a[208:211], v[84:87], a[68:71]
    v_exp_f32 v130, v58
    v_mfma_f32_16x16x32_bf16 a[72:75], a[208:211], v[88:91], a[72:75]
    v_cvt_pk_bf16_f32 v104, v128, v129
    v_add_f32 v142, v142, v130
    v_mfma_f32_16x16x32_bf16 a[76:79], a[208:211], v[92:95], a[76:79]
    s_waitcnt lgkmcnt(2)
    v_exp_f32 v131, v59
    v_mfma_f32_16x16x32_bf16 a[80:83], a[212:215], v[80:83], a[80:83]
    v_add_f32 v142, v142, v131
    v_mfma_f32_16x16x32_bf16 a[84:87], a[212:215], v[84:87], a[84:87]
    v_exp_f32 v132, v60
    v_mfma_f32_16x16x32_bf16 a[88:91], a[212:215], v[88:91], a[88:91]
    v_cvt_pk_bf16_f32 v105, v130, v131
    v_add_f32 v147, v147, v139
    v_mfma_f32_16x16x32_bf16 a[92:95], a[212:215], v[92:95], a[92:95]
    s_waitcnt lgkmcnt(1)
    v_exp_f32 v133, v61
    v_mfma_f32_16x16x32_bf16 a[96:99], a[216:219], v[80:83], a[96:99]
    v_add_f32 v143, v132, v133
    v_mfma_f32_16x16x32_bf16 a[100:103], a[216:219], v[84:87], a[100:103]
    v_exp_f32 v134, v62
    v_mfma_f32_16x16x32_bf16 a[104:107], a[216:219], v[88:91], a[104:107]
    v_cvt_pk_bf16_f32 v108, v132, v133
    v_add_f32 v143, v143, v134
    v_mfma_f32_16x16x32_bf16 a[108:111], a[216:219], v[92:95], a[108:111]
    s_waitcnt lgkmcnt(0)
    v_exp_f32 v135, v63
    v_mfma_f32_16x16x32_bf16 a[112:115], a[220:223], v[80:83], a[112:115]
    v_add_f32 v143, v143, v135
    v_mfma_f32_16x16x32_bf16 a[116:119], a[220:223], v[84:87], a[116:119]
    v_exp_f32 v128, v64
    v_mfma_f32_16x16x32_bf16 a[120:123], a[220:223], v[88:91], a[120:123]
    v_cvt_pk_bf16_f32 v109, v134, v135
    v_add_f32 v140, v140, v128
    v_mfma_f32_16x16x32_bf16 a[124:127], a[220:223], v[92:95], a[124:127]
    v_exp_f32 v129, v65
    s_nop 0
    v_add_f32 v140, v140, v129
    v_exp_f32 v130, v66
    v_cvt_pk_bf16_f32 v98, v128, v129
    v_add_f32 v140, v140, v130
    v_exp_f32 v131, v67
    ds_read_b128 a[192:195], v2 offset:49152
    v_add_f32 v140, v140, v131
    v_exp_f32 v132, v68
    v_cvt_pk_bf16_f32 v99, v130, v131
    v_add_f32 v141, v141, v132
    v_exp_f32 v133, v69
    ds_read_b128 a[196:199], v2 offset:50176
    v_add_f32 v141, v141, v133
    v_exp_f32 v134, v70
    v_cvt_pk_bf16_f32 v102, v132, v133
    v_add_f32 v141, v141, v134
    v_exp_f32 v135, v71
    ds_read_b128 a[200:203], v2 offset:51200
    v_add_f32 v141, v141, v135
    v_exp_f32 v128, v72
    v_cvt_pk_bf16_f32 v103, v134, v135
    v_add_f32 v142, v142, v128
    v_exp_f32 v129, v73
    ds_read_b128 a[204:207], v2 offset:52224
    v_add_f32 v142, v142, v129
    v_exp_f32 v130, v74
    v_cvt_pk_bf16_f32 v106, v128, v129
    v_add_f32 v142, v142, v130
    v_exp_f32 v131, v75
    ds_read_b128 a[208:211], v2 offset:53248
    v_add_f32 v142, v142, v131
    v_exp_f32 v132, v76
    v_cvt_pk_bf16_f32 v107, v130, v131
    v_add_f32 v143, v143, v132
    v_exp_f32 v133, v77
    ds_read_b128 a[212:215], v2 offset:54272
    v_add_f32 v143, v143, v133
    v_exp_f32 v134, v78
    v_max3_f32 v148, v140, v141, v142
    v_cvt_pk_bf16_f32 v110, v132, v133
    v_add_f32 v143, v143, v134
    v_exp_f32 v135, v79
    ds_read_b128 a[216:219], v2 offset:55296
    v_add_f32 v143, v143, v135
    v_max_f32 v148, v148, v143
    v_cvt_pk_bf16_f32 v111, v134, v135
    v_cmp_lt_f32 vcc, s18, v148
    s_waitcnt lgkmcnt(6)
    s_cbranch_vccnz L_tramp_14
L_back_14:
    v_mfma_f32_16x16x32_bf16 a[0:3], a[192:195], v[96:99], a[0:3]
    ds_read_b128 a[220:223], v2 offset:56320
    v_mfma_f32_16x16x32_bf16 a[4:7], a[192:195], v[100:103], a[4:7]
    v_add_f32 v144, v144, v140
    v_mfma_f32_16x16x32_bf16 a[8:11], a[192:195], v[104:107], a[8:11]
    v_add_f32 v145, v145, v141
    v_mfma_f32_16x16x32_bf16 a[12:15], a[192:195], v[108:111], a[12:15]
    s_waitcnt lgkmcnt(6)
    v_mfma_f32_16x16x32_bf16 a[16:19], a[196:199], v[96:99], a[16:19]
    v_mfma_f32_16x16x32_bf16 a[20:23], a[196:199], v[100:103], a[20:23]
    v_mfma_f32_16x16x32_bf16 a[24:27], a[196:199], v[104:107], a[24:27]
    v_add_f32 v146, v146, v142
    v_mfma_f32_16x16x32_bf16 a[28:31], a[196:199], v[108:111], a[28:31]
    s_waitcnt lgkmcnt(5)
    v_mfma_f32_16x16x32_bf16 a[32:35], a[200:203], v[96:99], a[32:35]
    v_mfma_f32_16x16x32_bf16 a[36:39], a[200:203], v[100:103], a[36:39]
    v_mfma_f32_16x16x32_bf16 a[40:43], a[200:203], v[104:107], a[40:43]
    v_add_f32 v147, v147, v143
    v_mfma_f32_16x16x32_bf16 a[44:47], a[200:203], v[108:111], a[44:47]
    s_waitcnt lgkmcnt(4)
    v_mfma_f32_16x16x32_bf16 a[48:51], a[204:207], v[96:99], a[48:51]
    v_mfma_f32_16x16x32_bf16 a[52:55], a[204:207], v[100:103], a[52:55]
    v_mfma_f32_16x16x32_bf16 a[56:59], a[204:207], v[104:107], a[56:59]
    v_mfma_f32_16x16x32_bf16 a[60:63], a[204:207], v[108:111], a[60:63]
    s_waitcnt lgkmcnt(3)
    v_mfma_f32_16x16x32_bf16 a[64:67], a[208:211], v[96:99], a[64:67]
    v_mfma_f32_16x16x32_bf16 a[68:71], a[208:211], v[100:103], a[68:71]
    v_mfma_f32_16x16x32_bf16 a[72:75], a[208:211], v[104:107], a[72:75]
    v_mfma_f32_16x16x32_bf16 a[76:79], a[208:211], v[108:111], a[76:79]
    s_waitcnt lgkmcnt(2)
    v_mfma_f32_16x16x32_bf16 a[80:83], a[212:215], v[96:99], a[80:83]
    v_mfma_f32_16x16x32_bf16 a[84:87], a[212:215], v[100:103], a[84:87]
    v_mfma_f32_16x16x32_bf16 a[88:91], a[212:215], v[104:107], a[88:91]
    v_mfma_f32_16x16x32_bf16 a[92:95], a[212:215], v[108:111], a[92:95]
    s_waitcnt lgkmcnt(1)
    v_mfma_f32_16x16x32_bf16 a[96:99], a[216:219], v[96:99], a[96:99]
    v_mfma_f32_16x16x32_bf16 a[100:103], a[216:219], v[100:103], a[100:103]
    v_mfma_f32_16x16x32_bf16 a[104:107], a[216:219], v[104:107], a[104:107]
    v_mfma_f32_16x16x32_bf16 a[108:111], a[216:219], v[108:111], a[108:111]
    s_waitcnt lgkmcnt(0)
    v_mfma_f32_16x16x32_bf16 a[112:115], a[220:223], v[96:99], a[112:115]
    v_mfma_f32_16x16x32_bf16 a[116:119], a[220:223], v[100:103], a[116:119]
    v_mfma_f32_16x16x32_bf16 a[120:123], a[220:223], v[104:107], a[120:123]
    v_mfma_f32_16x16x32_bf16 a[124:127], a[220:223], v[108:111], a[124:127]
    v_mov_b32 v158, v144
    s_nop 1
    v_permlane16_swap_b32 v144, v158
    v_add_f32 v144, v144, v158
    v_mov_b32 v158, v144
    s_nop 1
    v_permlane32_swap_b32 v144, v158
    v_add_f32 v144, v144, v158
    v_mov_b32 v158, v145
    s_nop 1
    v_permlane16_swap_b32 v145, v158
    v_add_f32 v145, v145, v158
    v_mov_b32 v158, v145
    s_nop 1
    v_permlane32_swap_b32 v145, v158
    v_add_f32 v145, v145, v158
    v_mov_b32 v158, v146
    s_nop 1
    v_permlane16_swap_b32 v146, v158
    v_add_f32 v146, v146, v158
    v_mov_b32 v158, v146
    s_nop 1
    v_permlane32_swap_b32 v146, v158
    v_add_f32 v146, v146, v158
    v_mov_b32 v158, v147
    s_nop 1
    v_permlane16_swap_b32 v147, v158
    v_add_f32 v147, v147, v158
    v_mov_b32 v158, v147
    s_nop 1
    v_permlane32_swap_b32 v147, v158
    v_add_f32 v147, v147, v158
    v_rcp_f32 v150, v144
    v_rcp_f32 v152, v145
    v_rcp_f32 v154, v146
    v_rcp_f32 v156, v147
    s_nop 3
    v_accvgpr_read_b32 v176, a0
    v_accvgpr_read_b32 v177, a16
    v_accvgpr_read_b32 v178, a32
    v_accvgpr_read_b32 v179, a48
    v_accvgpr_read_b32 v180, a1
    v_accvgpr_read_b32 v181, a17
    v_accvgpr_read_b32 v182, a33
    v_accvgpr_read_b32 v183, a49
    v_accvgpr_read_b32 v184, a2
    v_accvgpr_read_b32 v185, a18
    v_accvgpr_read_b32 v186, a34
    v_accvgpr_read_b32 v187, a50
    v_accvgpr_read_b32 v188, a3
    v_accvgpr_read_b32 v189, a19
    v_accvgpr_read_b32 v190, a35
    v_accvgpr_read_b32 v191, a51
    v_pk_mul_f32 v[176:177], v[176:177], v[150:151] op_sel:[0,0] op_sel_hi:[1,0]
    v_pk_mul_f32 v[178:179], v[178:179], v[150:151] op_sel:[0,0] op_sel_hi:[1,0]
    v_pk_mul_f32 v[180:181], v[180:181], v[150:151] op_sel:[0,0] op_sel_hi:[1,0]
    v_pk_mul_f32 v[182:183], v[182:183], v[150:151] op_sel:[0,0] op_sel_hi:[1,0]
    v_pk_mul_f32 v[184:185], v[184:185], v[150:151] op_sel:[0,0] op_sel_hi:[1,0]
    v_pk_mul_f32 v[186:187], v[186:187], v[150:151] op_sel:[0,0] op_sel_hi:[1,0]
    v_pk_mul_f32 v[188:189], v[188:189], v[150:151] op_sel:[0,0] op_sel_hi:[1,0]
    v_pk_mul_f32 v[190:191], v[190:191], v[150:151] op_sel:[0,0] op_sel_hi:[1,0]
    v_cvt_pk_bf16_f32 v192, v176, v177
    v_cvt_pk_bf16_f32 v193, v178, v179
    v_cvt_pk_bf16_f32 v194, v180, v181
    v_cvt_pk_bf16_f32 v195, v182, v183
    v_cvt_pk_bf16_f32 v196, v184, v185
    v_cvt_pk_bf16_f32 v197, v186, v187
    v_cvt_pk_bf16_f32 v198, v188, v189
    v_cvt_pk_bf16_f32 v199, v190, v191
    buffer_store_dwordx4 v[192:195], v10, s[12:15], s88 offen offset:0 sc1
    buffer_store_dwordx4 v[196:199], v10, s[12:15], s88 offen offset:64 sc1
    v_accvgpr_read_b32 v200, a4
    v_accvgpr_read_b32 v201, a20
    v_accvgpr_read_b32 v202, a36
    v_accvgpr_read_b32 v203, a52
    v_accvgpr_read_b32 v204, a5
    v_accvgpr_read_b32 v205, a21
    v_accvgpr_read_b32 v206, a37
    v_accvgpr_read_b32 v207, a53
    v_accvgpr_read_b32 v208, a6
    v_accvgpr_read_b32 v209, a22
    v_accvgpr_read_b32 v210, a38
    v_accvgpr_read_b32 v211, a54
    v_accvgpr_read_b32 v212, a7
    v_accvgpr_read_b32 v213, a23
    v_accvgpr_read_b32 v214, a39
    v_accvgpr_read_b32 v215, a55
    v_pk_mul_f32 v[200:201], v[200:201], v[152:153] op_sel:[0,0] op_sel_hi:[1,0]
    v_pk_mul_f32 v[202:203], v[202:203], v[152:153] op_sel:[0,0] op_sel_hi:[1,0]
    v_pk_mul_f32 v[204:205], v[204:205], v[152:153] op_sel:[0,0] op_sel_hi:[1,0]
    v_pk_mul_f32 v[206:207], v[206:207], v[152:153] op_sel:[0,0] op_sel_hi:[1,0]
    v_pk_mul_f32 v[208:209], v[208:209], v[152:153] op_sel:[0,0] op_sel_hi:[1,0]
    v_pk_mul_f32 v[210:211], v[210:211], v[152:153] op_sel:[0,0] op_sel_hi:[1,0]
    v_pk_mul_f32 v[212:213], v[212:213], v[152:153] op_sel:[0,0] op_sel_hi:[1,0]
    v_pk_mul_f32 v[214:215], v[214:215], v[152:153] op_sel:[0,0] op_sel_hi:[1,0]
    v_cvt_pk_bf16_f32 v216, v200, v201
    v_cvt_pk_bf16_f32 v217, v202, v203
    v_cvt_pk_bf16_f32 v218, v204, v205
    v_cvt_pk_bf16_f32 v219, v206, v207
    v_cvt_pk_bf16_f32 v220, v208, v209
    v_cvt_pk_bf16_f32 v221, v210, v211
    v_cvt_pk_bf16_f32 v222, v212, v213
    v_cvt_pk_bf16_f32 v223, v214, v215
    buffer_store_dwordx4 v[216:219], v10, s[12:15], s89 offen offset:0 sc1
    buffer_store_dwordx4 v[220:223], v10, s[12:15], s89 offen offset:64 sc1
    v_accvgpr_read_b32 v224, a8
    v_accvgpr_read_b32 v225, a24
    v_accvgpr_read_b32 v226, a40
    v_accvgpr_read_b32 v227, a56
    v_accvgpr_read_b32 v228, a9
    v_accvgpr_read_b32 v229, a25
    v_accvgpr_read_b32 v230, a41
    v_accvgpr_read_b32 v231, a57
    v_accvgpr_read_b32 v232, a10
    v_accvgpr_read_b32 v233, a26
    v_accvgpr_read_b32 v234, a42
    v_accvgpr_read_b32 v235, a58
    v_accvgpr_read_b32 v236, a11
    v_accvgpr_read_b32 v237, a27
    v_accvgpr_read_b32 v238, a43
    v_accvgpr_read_b32 v239, a59
    v_pk_mul_f32 v[224:225], v[224:225], v[154:155] op_sel:[0,0] op_sel_hi:[1,0]
    v_pk_mul_f32 v[226:227], v[226:227], v[154:155] op_sel:[0,0] op_sel_hi:[1,0]
    v_pk_mul_f32 v[228:229], v[228:229], v[154:155] op_sel:[0,0] op_sel_hi:[1,0]
    v_pk_mul_f32 v[230:231], v[230:231], v[154:155] op_sel:[0,0] op_sel_hi:[1,0]
    v_pk_mul_f32 v[232:233], v[232:233], v[154:155] op_sel:[0,0] op_sel_hi:[1,0]
    v_pk_mul_f32 v[234:235], v[234:235], v[154:155] op_sel:[0,0] op_sel_hi:[1,0]
    v_pk_mul_f32 v[236:237], v[236:237], v[154:155] op_sel:[0,0] op_sel_hi:[1,0]
    v_pk_mul_f32 v[238:239], v[238:239], v[154:155] op_sel:[0,0] op_sel_hi:[1,0]
    v_cvt_pk_bf16_f32 v240, v224, v225
    v_cvt_pk_bf16_f32 v241, v226, v227
    v_cvt_pk_bf16_f32 v242, v228, v229
    v_cvt_pk_bf16_f32 v243, v230, v231
    v_cvt_pk_bf16_f32 v244, v232, v233
    v_cvt_pk_bf16_f32 v245, v234, v235
    v_cvt_pk_bf16_f32 v246, v236, v237
    v_cvt_pk_bf16_f32 v247, v238, v239
    buffer_store_dwordx4 v[240:243], v10, s[12:15], s90 offen offset:0 sc1
    buffer_store_dwordx4 v[244:247], v10, s[12:15], s90 offen offset:64 sc1
    v_accvgpr_read_b32 v176, a12
    v_accvgpr_read_b32 v177, a28
    v_accvgpr_read_b32 v178, a44
    v_accvgpr_read_b32 v179, a60
    v_accvgpr_read_b32 v180, a13
    v_accvgpr_read_b32 v181, a29
    v_accvgpr_read_b32 v182, a45
    v_accvgpr_read_b32 v183, a61
    v_accvgpr_read_b32 v184, a14
    v_accvgpr_read_b32 v185, a30
    v_accvgpr_read_b32 v186, a46
    v_accvgpr_read_b32 v187, a62
    v_accvgpr_read_b32 v188, a15
    v_accvgpr_read_b32 v189, a31
    v_accvgpr_read_b32 v190, a47
    v_accvgpr_read_b32 v191, a63
    v_pk_mul_f32 v[176:177], v[176:177], v[156:157] op_sel:[0,0] op_sel_hi:[1,0]
    v_pk_mul_f32 v[178:179], v[178:179], v[156:157] op_sel:[0,0] op_sel_hi:[1,0]
    v_pk_mul_f32 v[180:181], v[180:181], v[156:157] op_sel:[0,0] op_sel_hi:[1,0]
    v_pk_mul_f32 v[182:183], v[182:183], v[156:157] op_sel:[0,0] op_sel_hi:[1,0]
    v_pk_mul_f32 v[184:185], v[184:185], v[156:157] op_sel:[0,0] op_sel_hi:[1,0]
    v_pk_mul_f32 v[186:187], v[186:187], v[156:157] op_sel:[0,0] op_sel_hi:[1,0]
    v_pk_mul_f32 v[188:189], v[188:189], v[156:157] op_sel:[0,0] op_sel_hi:[1,0]
    v_pk_mul_f32 v[190:191], v[190:191], v[156:157] op_sel:[0,0] op_sel_hi:[1,0]
    v_cvt_pk_bf16_f32 v192, v176, v177
    v_cvt_pk_bf16_f32 v193, v178, v179
    v_cvt_pk_bf16_f32 v194, v180, v181
    v_cvt_pk_bf16_f32 v195, v182, v183
    v_cvt_pk_bf16_f32 v196, v184, v185
    v_cvt_pk_bf16_f32 v197, v186, v187
    v_cvt_pk_bf16_f32 v198, v188, v189
    v_cvt_pk_bf16_f32 v199, v190, v191
    buffer_store_dwordx4 v[192:195], v10, s[12:15], s91 offen offset:0 sc1
    buffer_store_dwordx4 v[196:199], v10, s[12:15], s91 offen offset:64 sc1
    v_accvgpr_read_b32 v200, a64
    v_accvgpr_read_b32 v201, a80
    v_accvgpr_read_b32 v202, a96
    v_accvgpr_read_b32 v203, a112
    v_accvgpr_read_b32 v204, a65
    v_accvgpr_read_b32 v205, a81
    v_accvgpr_read_b32 v206, a97
    v_accvgpr_read_b32 v207, a113
    v_accvgpr_read_b32 v208, a66
    v_accvgpr_read_b32 v209, a82
    v_accvgpr_read_b32 v210, a98
    v_accvgpr_read_b32 v211, a114
    v_accvgpr_read_b32 v212, a67
    v_accvgpr_read_b32 v213, a83
    v_accvgpr_read_b32 v214, a99
    v_accvgpr_read_b32 v215, a115
    v_pk_mul_f32 v[200:201], v[200:201], v[150:151] op_sel:[0,0] op_sel_hi:[1,0]
    v_pk_mul_f32 v[202:203], v[202:203], v[150:151] op_sel:[0,0] op_sel_hi:[1,0]
    v_pk_mul_f32 v[204:205], v[204:205], v[150:151] op_sel:[0,0] op_sel_hi:[1,0]
    v_pk_mul_f32 v[206:207], v[206:207], v[150:151] op_sel:[0,0] op_sel_hi:[1,0]
    v_pk_mul_f32 v[208:209], v[208:209], v[150:151] op_sel:[0,0] op_sel_hi:[1,0]
    v_pk_mul_f32 v[210:211], v[210:211], v[150:151] op_sel:[0,0] op_sel_hi:[1,0]
    v_pk_mul_f32 v[212:213], v[212:213], v[150:151] op_sel:[0,0] op_sel_hi:[1,0]
    v_pk_mul_f32 v[214:215], v[214:215], v[150:151] op_sel:[0,0] op_sel_hi:[1,0]
    v_cvt_pk_bf16_f32 v216, v200, v201
    v_cvt_pk_bf16_f32 v217, v202, v203
    v_cvt_pk_bf16_f32 v218, v204, v205
    v_cvt_pk_bf16_f32 v219, v206, v207
    v_cvt_pk_bf16_f32 v220, v208, v209
    v_cvt_pk_bf16_f32 v221, v210, v211
    v_cvt_pk_bf16_f32 v222, v212, v213
    v_cvt_pk_bf16_f32 v223, v214, v215
    buffer_store_dwordx4 v[216:219], v10, s[12:15], s88 offen offset:128 sc1
    buffer_store_dwordx4 v[220:223], v10, s[12:15], s88 offen offset:192 sc1
    v_accvgpr_read_b32 v224, a68
    v_accvgpr_read_b32 v225, a84
    v_accvgpr_read_b32 v226, a100
    v_accvgpr_read_b32 v227, a116
    v_accvgpr_read_b32 v228, a69
    v_accvgpr_read_b32 v229, a85
    v_accvgpr_read_b32 v230, a101
    v_accvgpr_read_b32 v231, a117
    v_accvgpr_read_b32 v232, a70
    v_accvgpr_read_b32 v233, a86
    v_accvgpr_read_b32 v234, a102
    v_accvgpr_read_b32 v235, a118
    v_accvgpr_read_b32 v236, a71
    v_accvgpr_read_b32 v237, a87
    v_accvgpr_read_b32 v238, a103
    v_accvgpr_read_b32 v239, a119
    v_pk_mul_f32 v[224:225], v[224:225], v[152:153] op_sel:[0,0] op_sel_hi:[1,0]
    v_pk_mul_f32 v[226:227], v[226:227], v[152:153] op_sel:[0,0] op_sel_hi:[1,0]
    v_pk_mul_f32 v[228:229], v[228:229], v[152:153] op_sel:[0,0] op_sel_hi:[1,0]
    v_pk_mul_f32 v[230:231], v[230:231], v[152:153] op_sel:[0,0] op_sel_hi:[1,0]
    v_pk_mul_f32 v[232:233], v[232:233], v[152:153] op_sel:[0,0] op_sel_hi:[1,0]
    v_pk_mul_f32 v[234:235], v[234:235], v[152:153] op_sel:[0,0] op_sel_hi:[1,0]
    v_pk_mul_f32 v[236:237], v[236:237], v[152:153] op_sel:[0,0] op_sel_hi:[1,0]
    v_pk_mul_f32 v[238:239], v[238:239], v[152:153] op_sel:[0,0] op_sel_hi:[1,0]
    v_cvt_pk_bf16_f32 v240, v224, v225
    v_cvt_pk_bf16_f32 v241, v226, v227
    v_cvt_pk_bf16_f32 v242, v228, v229
    v_cvt_pk_bf16_f32 v243, v230, v231
    v_cvt_pk_bf16_f32 v244, v232, v233
    v_cvt_pk_bf16_f32 v245, v234, v235
    v_cvt_pk_bf16_f32 v246, v236, v237
    v_cvt_pk_bf16_f32 v247, v238, v239
    buffer_store_dwordx4 v[240:243], v10, s[12:15], s89 offen offset:128 sc1
    buffer_store_dwordx4 v[244:247], v10, s[12:15], s89 offen offset:192 sc1
    v_accvgpr_read_b32 v176, a72
    v_accvgpr_read_b32 v177, a88
    v_accvgpr_read_b32 v178, a104
    v_accvgpr_read_b32 v179, a120
    v_accvgpr_read_b32 v180, a73
    v_accvgpr_read_b32 v181, a89
    v_accvgpr_read_b32 v182, a105
    v_accvgpr_read_b32 v183, a121
    v_accvgpr_read_b32 v184, a74
    v_accvgpr_read_b32 v185, a90
    v_accvgpr_read_b32 v186, a106
    v_accvgpr_read_b32 v187, a122
    v_accvgpr_read_b32 v188, a75
    v_accvgpr_read_b32 v189, a91
    v_accvgpr_read_b32 v190, a107
    v_accvgpr_read_b32 v191, a123
    v_pk_mul_f32 v[176:177], v[176:177], v[154:155] op_sel:[0,0] op_sel_hi:[1,0]
    v_pk_mul_f32 v[178:179], v[178:179], v[154:155] op_sel:[0,0] op_sel_hi:[1,0]
    v_pk_mul_f32 v[180:181], v[180:181], v[154:155] op_sel:[0,0] op_sel_hi:[1,0]
    v_pk_mul_f32 v[182:183], v[182:183], v[154:155] op_sel:[0,0] op_sel_hi:[1,0]
    v_pk_mul_f32 v[184:185], v[184:185], v[154:155] op_sel:[0,0] op_sel_hi:[1,0]
    v_pk_mul_f32 v[186:187], v[186:187], v[154:155] op_sel:[0,0] op_sel_hi:[1,0]
    v_pk_mul_f32 v[188:189], v[188:189], v[154:155] op_sel:[0,0] op_sel_hi:[1,0]
    v_pk_mul_f32 v[190:191], v[190:191], v[154:155] op_sel:[0,0] op_sel_hi:[1,0]
    v_cvt_pk_bf16_f32 v192, v176, v177
    v_cvt_pk_bf16_f32 v193, v178, v179
    v_cvt_pk_bf16_f32 v194, v180, v181
    v_cvt_pk_bf16_f32 v195, v182, v183
    v_cvt_pk_bf16_f32 v196, v184, v185
    v_cvt_pk_bf16_f32 v197, v186, v187
    v_cvt_pk_bf16_f32 v198, v188, v189
    v_cvt_pk_bf16_f32 v199, v190, v191
    buffer_store_dwordx4 v[192:195], v10, s[12:15], s90 offen offset:128 sc1
    buffer_store_dwordx4 v[196:199], v10, s[12:15], s90 offen offset:192 sc1
    v_accvgpr_read_b32 v200, a76
    v_accvgpr_read_b32 v201, a92
    v_accvgpr_read_b32 v202, a108
    v_accvgpr_read_b32 v203, a124
    v_accvgpr_read_b32 v204, a77
    v_accvgpr_read_b32 v205, a93
    v_accvgpr_read_b32 v206, a109
    v_accvgpr_read_b32 v207, a125
    v_accvgpr_read_b32 v208, a78
    v_accvgpr_read_b32 v209, a94
    v_accvgpr_read_b32 v210, a110
    v_accvgpr_read_b32 v211, a126
    v_accvgpr_read_b32 v212, a79
    v_accvgpr_read_b32 v213, a95
    v_accvgpr_read_b32 v214, a111
    v_accvgpr_read_b32 v215, a127
    v_pk_mul_f32 v[200:201], v[200:201], v[156:157] op_sel:[0,0] op_sel_hi:[1,0]
    v_pk_mul_f32 v[202:203], v[202:203], v[156:157] op_sel:[0,0] op_sel_hi:[1,0]
    v_pk_mul_f32 v[204:205], v[204:205], v[156:157] op_sel:[0,0] op_sel_hi:[1,0]
    v_pk_mul_f32 v[206:207], v[206:207], v[156:157] op_sel:[0,0] op_sel_hi:[1,0]
    v_pk_mul_f32 v[208:209], v[208:209], v[156:157] op_sel:[0,0] op_sel_hi:[1,0]
    v_pk_mul_f32 v[210:211], v[210:211], v[156:157] op_sel:[0,0] op_sel_hi:[1,0]
    v_pk_mul_f32 v[212:213], v[212:213], v[156:157] op_sel:[0,0] op_sel_hi:[1,0]
    v_pk_mul_f32 v[214:215], v[214:215], v[156:157] op_sel:[0,0] op_sel_hi:[1,0]
    v_cvt_pk_bf16_f32 v216, v200, v201
    v_cvt_pk_bf16_f32 v217, v202, v203
    v_cvt_pk_bf16_f32 v218, v204, v205
    v_cvt_pk_bf16_f32 v219, v206, v207
    v_cvt_pk_bf16_f32 v220, v208, v209
    v_cvt_pk_bf16_f32 v221, v210, v211
    v_cvt_pk_bf16_f32 v222, v212, v213
    v_cvt_pk_bf16_f32 v223, v214, v215
    buffer_store_dwordx4 v[216:219], v10, s[12:15], s91 offen offset:128 sc1
    buffer_store_dwordx4 v[220:223], v10, s[12:15], s91 offen offset:192 sc1
L_done:
    s_endpgm
L_tramp_0:
    s_call_b64 s[86:87], L_slow_1
    s_branch L_back_0
L_tramp_1:
    s_call_b64 s[86:87], L_slow_0
    s_branch L_back_1
L_tramp_2:
    s_call_b64 s[86:87], L_slow_1
    s_branch L_back_2
L_tramp_3:
    s_call_b64 s[86:87], L_slow_0
    s_branch L_back_3
L_tramp_4:
    s_call_b64 s[86:87], L_slow_1
    s_branch L_back_4
L_tramp_5:
    s_call_b64 s[86:87], L_slow_0
    s_branch L_back_5
L_tramp_6:
    s_call_b64 s[86:87], L_slow_1
    s_branch L_back_6
L_tramp_7:
    s_call_b64 s[86:87], L_slow_0
    s_branch L_back_7
L_tramp_8:
    s_call_b64 s[86:87], L_slow_1
    s_branch L_back_8
L_tramp_9:
    s_call_b64 s[86:87], L_slow_0
    s_branch L_back_9
L_tramp_10:
    s_call_b64 s[86:87], L_slow_1
    s_branch L_back_10
L_tramp_11:
    s_call_b64 s[86:87], L_slow_0
    s_branch L_back_11
L_tramp_12:
    s_call_b64 s[86:87], L_slow_1
    s_branch L_back_12
L_tramp_13:
    s_call_b64 s[86:87], L_slow_0
    s_branch L_back_13
L_tramp_14:
    s_call_b64 s[86:87], L_slow_1
    s_branch L_back_14
L_slow_0:
    s_nop 15
    v_max3_f32 v150, v16, v17, v18
    v_max3_f32 v150, v150, v19, v32
    v_max3_f32 v150, v150, v33, v34
    v_max_f32 v150, v150, v35
    v_mov_b32 v158, v150
    s_nop 1
    v_permlane16_swap_b32 v150, v158
    v_max_f32 v150, v150, v158
    v_mov_b32 v158, v150
    s_nop 1
    v_permlane32_swap_b32 v150, v158
    v_max_f32 v150, v150, v158
    v_ceil_f32 v150, v150
    v_max_f32 v150, 0, v150
    v_exp_f32 v154, -v150
    v_max3_f32 v151, v20, v21, v22
    v_max3_f32 v151, v151, v23, v36
    v_max3_f32 v151, v151, v37, v38
    v_max_f32 v151, v151, v39
    v_mov_b32 v158, v151
    s_nop 1
    v_permlane16_swap_b32 v151, v158
    v_max_f32 v151, v151, v158
    v_mov_b32 v158, v151
    s_nop 1
    v_permlane32_swap_b32 v151, v158
    v_max_f32 v151, v151, v158
    v_ceil_f32 v151, v151
    v_max_f32 v151, 0, v151
    v_exp_f32 v155, -v151
    v_max3_f32 v152, v24, v25, v26
    v_max3_f32 v152, v152, v27, v40
    v_max3_f32 v152, v152, v41, v42
    v_max_f32 v152, v152, v43
    v_mov_b32 v158, v152
    s_nop 1
    v_permlane16_swap_b32 v152, v158
    v_max_f32 v152, v152, v158
    v_mov_b32 v158, v152
    s_nop 1
    v_permlane32_swap_b32 v152, v158
    v_max_f32 v152, v152, v158
    v_ceil_f32 v152, v152
    v_max_f32 v152, 0, v152
    v_exp_f32 v156, -v152
    v_max3_f32 v153, v28, v29, v30
    v_max3_f32 v153, v153, v31, v44
    v_max3_f32 v153, v153, v45, v46
    v_max_f32 v153, v153, v47
    v_mov_b32 v158, v153
    s_nop 1
    v_permlane16_swap_b32 v153, v158
    v_max_f32 v153, v153, v158
    v_mov_b32 v158, v153
    s_nop 1
    v_permlane32_swap_b32 v153, v158
    v_max_f32 v153, v153, v158
    v_ceil_f32 v153, v153
    v_max_f32 v153, 0, v153
    v_exp_f32 v157, -v153
    v_sub_f32 v112, v112, v150
    v_sub_f32 v113, v113, v150
    v_sub_f32 v114, v114, v150
    v_sub_f32 v115, v115, v150
    v_sub_f32 v16, v16, v150
    v_sub_f32 v17, v17, v150
    v_sub_f32 v18, v18, v150
    v_sub_f32 v19, v19, v150
    v_sub_f32 v32, v32, v150
    v_sub_f32 v33, v33, v150
    v_sub_f32 v34, v34, v150
    v_sub_f32 v35, v35, v150
    v_sub_f32 v48, v48, v150
    v_sub_f32 v49, v49, v150
    v_sub_f32 v50, v50, v150
    v_sub_f32 v51, v51, v150
    v_sub_f32 v64, v64, v150
    v_sub_f32 v65, v65, v150
    v_sub_f32 v66, v66, v150
    v_sub_f32 v67, v67, v150
    v_mul_f32 v144, v144, v154
    v_accvgpr_read_b32 v160, a0
    v_mul_f32 v160, v160, v154
    v_accvgpr_write_b32 a0, v160
    v_accvgpr_read_b32 v161, a1
    v_mul_f32 v161, v161, v154
    v_accvgpr_write_b32 a1, v161
    v_accvgpr_read_b32 v162, a2
    v_mul_f32 v162, v162, v154
    v_accvgpr_write_b32 a2, v162
    v_accvgpr_read_b32 v163, a3
    v_mul_f32 v163, v163, v154
    v_accvgpr_write_b32 a3, v163
    v_accvgpr_read_b32 v164, a16
    v_mul_f32 v164, v164, v154
    v_accvgpr_write_b32 a16, v164
    v_accvgpr_read_b32 v165, a17
    v_mul_f32 v165, v165, v154
    v_accvgpr_write_b32 a17, v165
    v_accvgpr_read_b32 v166, a18
    v_mul_f32 v166, v166, v154
    v_accvgpr_write_b32 a18, v166
    v_accvgpr_read_b32 v167, a19
    v_mul_f32 v167, v167, v154
    v_accvgpr_write_b32 a19, v167
    v_accvgpr_read_b32 v160, a32
    v_mul_f32 v160, v160, v154
    v_accvgpr_write_b32 a32, v160
    v_accvgpr_read_b32 v161, a33
    v_mul_f32 v161, v161, v154
    v_accvgpr_write_b32 a33, v161
    v_accvgpr_read_b32 v162, a34
    v_mul_f32 v162, v162, v154
    v_accvgpr_write_b32 a34, v162
    v_accvgpr_read_b32 v163, a35
    v_mul_f32 v163, v163, v154
    v_accvgpr_write_b32 a35, v163
    v_accvgpr_read_b32 v164, a48
    v_mul_f32 v164, v164, v154
    v_accvgpr_write_b32 a48, v164
    v_accvgpr_read_b32 v165, a49
    v_mul_f32 v165, v165, v154
    v_accvgpr_write_b32 a49, v165
    v_accvgpr_read_b32 v166, a50
    v_mul_f32 v166, v166, v154
    v_accvgpr_write_b32 a50, v166
    v_accvgpr_read_b32 v167, a51
    v_mul_f32 v167, v167, v154
    v_accvgpr_write_b32 a51, v167
    v_accvgpr_read_b32 v160, a64
    v_mul_f32 v160, v160, v154
    v_accvgpr_write_b32 a64, v160
    v_accvgpr_read_b32 v161, a65
    v_mul_f32 v161, v161, v154
    v_accvgpr_write_b32 a65, v161
    v_accvgpr_read_b32 v162, a66
    v_mul_f32 v162, v162, v154
    v_accvgpr_write_b32 a66, v162
    v_accvgpr_read_b32 v163, a67
    v_mul_f32 v163, v163, v154
    v_accvgpr_write_b32 a67, v163
    v_accvgpr_read_b32 v164, a80
    v_mul_f32 v164, v164, v154
    v_accvgpr_write_b32 a80, v164
    v_accvgpr_read_b32 v165, a81
    v_mul_f32 v165, v165, v154
    v_accvgpr_write_b32 a81, v165
    v_accvgpr_read_b32 v166, a82
    v_mul_f32 v166, v166, v154
    v_accvgpr_write_b32 a82, v166
    v_accvgpr_read_b32 v167, a83
    v_mul_f32 v167, v167, v154
    v_accvgpr_write_b32 a83, v167
    v_accvgpr_read_b32 v160, a96
    v_mul_f32 v160, v160, v154
    v_accvgpr_write_b32 a96, v160
    v_accvgpr_read_b32 v161, a97
    v_mul_f32 v161, v161, v154
    v_accvgpr_write_b32 a97, v161
    v_accvgpr_read_b32 v162, a98
    v_mul_f32 v162, v162, v154
    v_accvgpr_write_b32 a98, v162
    v_accvgpr_read_b32 v163, a99
    v_mul_f32 v163, v163, v154
    v_accvgpr_write_b32 a99, v163
    v_accvgpr_read_b32 v164, a112
    v_mul_f32 v164, v164, v154
    v_accvgpr_write_b32 a112, v164
    v_accvgpr_read_b32 v165, a113
    v_mul_f32 v165, v165, v154
    v_accvgpr_write_b32 a113, v165
    v_accvgpr_read_b32 v166, a114
    v_mul_f32 v166, v166, v154
    v_accvgpr_write_b32 a114, v166
    v_accvgpr_read_b32 v167, a115
    v_mul_f32 v167, v167, v154
    v_accvgpr_write_b32 a115, v167
    v_sub_f32 v116, v116, v151
    v_sub_f32 v117, v117, v151
    v_sub_f32 v118, v118, v151
    v_sub_f32 v119, v119, v151
    v_sub_f32 v20, v20, v151
    v_sub_f32 v21, v21, v151
    v_sub_f32 v22, v22, v151
    v_sub_f32 v23, v23, v151
    v_sub_f32 v36, v36, v151
    v_sub_f32 v37, v37, v151
    v_sub_f32 v38, v38, v151
    v_sub_f32 v39, v39, v151
    v_sub_f32 v52, v52, v151
    v_sub_f32 v53, v53, v151
    v_sub_f32 v54, v54, v151
    v_sub_f32 v55, v55, v151
    v_sub_f32 v68, v68, v151
    v_sub_f32 v69, v69, v151
    v_sub_f32 v70, v70, v151
    v_sub_f32 v71, v71, v151
    v_mul_f32 v145, v145, v155
    v_accvgpr_read_b32 v160, a4
    v_mul_f32 v160, v160, v155
    v_accvgpr_write_b32 a4, v160
    v_accvgpr_read_b32 v161, a5
    v_mul_f32 v161, v161, v155
    v_accvgpr_write_b32 a5, v161
    v_accvgpr_read_b32 v162, a6
    v_mul_f32 v162, v162, v155
    v_accvgpr_write_b32 a6, v162
    v_accvgpr_read_b32 v163, a7
    v_mul_f32 v163, v163, v155
    v_accvgpr_write_b32 a7, v163
    v_accvgpr_read_b32 v164, a20
    v_mul_f32 v164, v164, v155
    v_accvgpr_write_b32 a20, v164
    v_accvgpr_read_b32 v165, a21
    v_mul_f32 v165, v165, v155
    v_accvgpr_write_b32 a21, v165
    v_accvgpr_read_b32 v166, a22
    v_mul_f32 v166, v166, v155
    v_accvgpr_write_b32 a22, v166
    v_accvgpr_read_b32 v167, a23
    v_mul_f32 v167, v167, v155
    v_accvgpr_write_b32 a23, v167
    v_accvgpr_read_b32 v160, a36
    v_mul_f32 v160, v160, v155
    v_accvgpr_write_b32 a36, v160
    v_accvgpr_read_b32 v161, a37
    v_mul_f32 v161, v161, v155
    v_accvgpr_write_b32 a37, v161
    v_accvgpr_read_b32 v162, a38
    v_mul_f32 v162, v162, v155
    v_accvgpr_write_b32 a38, v162
    v_accvgpr_read_b32 v163, a39
    v_mul_f32 v163, v163, v155
    v_accvgpr_write_b32 a39, v163
    v_accvgpr_read_b32 v164, a52
    v_mul_f32 v164, v164, v155
    v_accvgpr_write_b32 a52, v164
    v_accvgpr_read_b32 v165, a53
    v_mul_f32 v165, v165, v155
    v_accvgpr_write_b32 a53, v165
    v_accvgpr_read_b32 v166, a54
    v_mul_f32 v166, v166, v155
    v_accvgpr_write_b32 a54, v166
    v_accvgpr_read_b32 v167, a55
    v_mul_f32 v167, v167, v155
    v_accvgpr_write_b32 a55, v167
    v_accvgpr_read_b32 v160, a68
    v_mul_f32 v160, v160, v155
    v_accvgpr_write_b32 a68, v160
    v_accvgpr_read_b32 v161, a69
    v_mul_f32 v161, v161, v155
    v_accvgpr_write_b32 a69, v161
    v_accvgpr_read_b32 v162, a70
    v_mul_f32 v162, v162, v155
    v_accvgpr_write_b32 a70, v162
    v_accvgpr_read_b32 v163, a71
    v_mul_f32 v163, v163, v155
    v_accvgpr_write_b32 a71, v163
    v_accvgpr_read_b32 v164, a84
    v_mul_f32 v164, v164, v155
    v_accvgpr_write_b32 a84, v164
    v_accvgpr_read_b32 v165, a85
    v_mul_f32 v165, v165, v155
    v_accvgpr_write_b32 a85, v165
    v_accvgpr_read_b32 v166, a86
    v_mul_f32 v166, v166, v155
    v_accvgpr_write_b32 a86, v166
    v_accvgpr_read_b32 v167, a87
    v_mul_f32 v167, v167, v155
    v_accvgpr_write_b32 a87, v167
    v_accvgpr_read_b32 v160, a100
    v_mul_f32 v160, v160, v155
    v_accvgpr_write_b32 a100, v160
    v_accvgpr_read_b32 v161, a101
    v_mul_f32 v161, v161, v155
    v_accvgpr_write_b32 a101, v161
    v_accvgpr_read_b32 v162, a102
    v_mul_f32 v162, v162, v155
    v_accvgpr_write_b32 a102, v162
    v_accvgpr_read_b32 v163, a103
    v_mul_f32 v163, v163, v155
    v_accvgpr_write_b32 a103, v163
    v_accvgpr_read_b32 v164, a116
    v_mul_f32 v164, v164, v155
    v_accvgpr_write_b32 a116, v164
    v_accvgpr_read_b32 v165, a117
    v_mul_f32 v165, v165, v155
    v_accvgpr_write_b32 a117, v165
    v_accvgpr_read_b32 v166, a118
    v_mul_f32 v166, v166, v155
    v_accvgpr_write_b32 a118, v166
    v_accvgpr_read_b32 v167, a119
    v_mul_f32 v167, v167, v155
    v_accvgpr_write_b32 a119, v167
    v_sub_f32 v120, v120, v152
    v_sub_f32 v121, v121, v152
    v_sub_f32 v122, v122, v152
    v_sub_f32 v123, v123, v152
    v_sub_f32 v24, v24, v152
    v_sub_f32 v25, v25, v152
    v_sub_f32 v26, v26, v152
    v_sub_f32 v27, v27, v152
    v_sub_f32 v40, v40, v152
    v_sub_f32 v41, v41, v152
    v_sub_f32 v42, v42, v152
    v_sub_f32 v43, v43, v152
    v_sub_f32 v56, v56, v152
    v_sub_f32 v57, v57, v152
    v_sub_f32 v58, v58, v152
    v_sub_f32 v59, v59, v152
    v_sub_f32 v72, v72, v152
    v_sub_f32 v73, v73, v152
    v_sub_f32 v74, v74, v152
    v_sub_f32 v75, v75, v152
    v_mul_f32 v146, v146, v156
    v_accvgpr_read_b32 v160, a8
    v_mul_f32 v160, v160, v156
    v_accvgpr_write_b32 a8, v160
    v_accvgpr_read_b32 v161, a9
    v_mul_f32 v161, v161, v156
    v_accvgpr_write_b32 a9, v161
    v_accvgpr_read_b32 v162, a10
    v_mul_f32 v162, v162, v156
    v_accvgpr_write_b32 a10, v162
    v_accvgpr_read_b32 v163, a11
    v_mul_f32 v163, v163, v156
    v_accvgpr_write_b32 a11, v163
    v_accvgpr_read_b32 v164, a24
    v_mul_f32 v164, v164, v156
    v_accvgpr_write_b32 a24, v164
    v_accvgpr_read_b32 v165, a25
    v_mul_f32 v165, v165, v156
    v_accvgpr_write_b32 a25, v165
    v_accvgpr_read_b32 v166, a26
    v_mul_f32 v166, v166, v156
    v_accvgpr_write_b32 a26, v166
    v_accvgpr_read_b32 v167, a27
    v_mul_f32 v167, v167, v156
    v_accvgpr_write_b32 a27, v167
    v_accvgpr_read_b32 v160, a40
    v_mul_f32 v160, v160, v156
    v_accvgpr_write_b32 a40, v160
    v_accvgpr_read_b32 v161, a41
    v_mul_f32 v161, v161, v156
    v_accvgpr_write_b32 a41, v161
    v_accvgpr_read_b32 v162, a42
    v_mul_f32 v162, v162, v156
    v_accvgpr_write_b32 a42, v162
    v_accvgpr_read_b32 v163, a43
    v_mul_f32 v163, v163, v156
    v_accvgpr_write_b32 a43, v163
    v_accvgpr_read_b32 v164, a56
    v_mul_f32 v164, v164, v156
    v_accvgpr_write_b32 a56, v164
    v_accvgpr_read_b32 v165, a57
    v_mul_f32 v165, v165, v156
    v_accvgpr_write_b32 a57, v165
    v_accvgpr_read_b32 v166, a58
    v_mul_f32 v166, v166, v156
    v_accvgpr_write_b32 a58, v166
    v_accvgpr_read_b32 v167, a59
    v_mul_f32 v167, v167, v156
    v_accvgpr_write_b32 a59, v167
    v_accvgpr_read_b32 v160, a72
    v_mul_f32 v160, v160, v156
    v_accvgpr_write_b32 a72, v160
    v_accvgpr_read_b32 v161, a73
    v_mul_f32 v161, v161, v156
    v_accvgpr_write_b32 a73, v161
    v_accvgpr_read_b32 v162, a74
    v_mul_f32 v162, v162, v156
    v_accvgpr_write_b32 a74, v162
    v_accvgpr_read_b32 v163, a75
    v_mul_f32 v163, v163, v156
    v_accvgpr_write_b32 a75, v163
    v_accvgpr_read_b32 v164, a88
    v_mul_f32 v164, v164, v156
    v_accvgpr_write_b32 a88, v164
    v_accvgpr_read_b32 v165, a89
    v_mul_f32 v165, v165, v156
    v_accvgpr_write_b32 a89, v165
    v_accvgpr_read_b32 v166, a90
    v_mul_f32 v166, v166, v156
    v_accvgpr_write_b32 a90, v166
    v_accvgpr_read_b32 v167, a91
    v_mul_f32 v167, v167, v156
    v_accvgpr_write_b32 a91, v167
    v_accvgpr_read_b32 v160, a104
    v_mul_f32 v160, v160, v156
    v_accvgpr_write_b32 a104, v160
    v_accvgpr_read_b32 v161, a105
    v_mul_f32 v161, v161, v156
    v_accvgpr_write_b32 a105, v161
    v_accvgpr_read_b32 v162, a106
    v_mul_f32 v162, v162, v156
    v_accvgpr_write_b32 a106, v162
    v_accvgpr_read_b32 v163, a107
    v_mul_f32 v163, v163, v156
    v_accvgpr_write_b32 a107, v163
    v_accvgpr_read_b32 v164, a120
    v_mul_f32 v164, v164, v156
    v_accvgpr_write_b32 a120, v164
    v_accvgpr_read_b32 v165, a121
    v_mul_f32 v165, v165, v156
    v_accvgpr_write_b32 a121, v165
    v_accvgpr_read_b32 v166, a122
    v_mul_f32 v166, v166, v156
    v_accvgpr_write_b32 a122, v166
    v_accvgpr_read_b32 v167, a123
    v_mul_f32 v167, v167, v156
    v_accvgpr_write_b32 a123, v167
    v_sub_f32 v124, v124, v153
    v_sub_f32 v125, v125, v153
    v_sub_f32 v126, v126, v153
    v_sub_f32 v127, v127, v153
    v_sub_f32 v28, v28, v153
    v_sub_f32 v29, v29, v153
    v_sub_f32 v30, v30, v153
    v_sub_f32 v31, v31, v153
    v_sub_f32 v44, v44, v153
    v_sub_f32 v45, v45, v153
    v_sub_f32 v46, v46, v153
    v_sub_f32 v47, v47, v153
    v_sub_f32 v60, v60, v153
    v_sub_f32 v61, v61, v153
    v_sub_f32 v62, v62, v153
    v_sub_f32 v63, v63, v153
    v_sub_f32 v76, v76, v153
    v_sub_f32 v77, v77, v153
    v_sub_f32 v78, v78, v153
    v_sub_f32 v79, v79, v153
    v_mul_f32 v147, v147, v157
    v_accvgpr_read_b32 v160, a12
    v_mul_f32 v160, v160, v157
    v_accvgpr_write_b32 a12, v160
    v_accvgpr_read_b32 v161, a13
    v_mul_f32 v161, v161, v157
    v_accvgpr_write_b32 a13, v161
    v_accvgpr_read_b32 v162, a14
    v_mul_f32 v162, v162, v157
    v_accvgpr_write_b32 a14, v162
    v_accvgpr_read_b32 v163, a15
    v_mul_f32 v163, v163, v157
    v_accvgpr_write_b32 a15, v163
    v_accvgpr_read_b32 v164, a28
    v_mul_f32 v164, v164, v157
    v_accvgpr_write_b32 a28, v164
    v_accvgpr_read_b32 v165, a29
    v_mul_f32 v165, v165, v157
    v_accvgpr_write_b32 a29, v165
    v_accvgpr_read_b32 v166, a30
    v_mul_f32 v166, v166, v157
    v_accvgpr_write_b32 a30, v166
    v_accvgpr_read_b32 v167, a31
    v_mul_f32 v167, v167, v157
    v_accvgpr_write_b32 a31, v167
    v_accvgpr_read_b32 v160, a44
    v_mul_f32 v160, v160, v157
    v_accvgpr_write_b32 a44, v160
    v_accvgpr_read_b32 v161, a45
    v_mul_f32 v161, v161, v157
    v_accvgpr_write_b32 a45, v161
    v_accvgpr_read_b32 v162, a46
    v_mul_f32 v162, v162, v157
    v_accvgpr_write_b32 a46, v162
    v_accvgpr_read_b32 v163, a47
    v_mul_f32 v163, v163, v157
    v_accvgpr_write_b32 a47, v163
    v_accvgpr_read_b32 v164, a60
    v_mul_f32 v164, v164, v157
    v_accvgpr_write_b32 a60, v164
    v_accvgpr_read_b32 v165, a61
    v_mul_f32 v165, v165, v157
    v_accvgpr_write_b32 a61, v165
    v_accvgpr_read_b32 v166, a62
    v_mul_f32 v166, v166, v157
    v_accvgpr_write_b32 a62, v166
    v_accvgpr_read_b32 v167, a63
    v_mul_f32 v167, v167, v157
    v_accvgpr_write_b32 a63, v167
    v_accvgpr_read_b32 v160, a76
    v_mul_f32 v160, v160, v157
    v_accvgpr_write_b32 a76, v160
    v_accvgpr_read_b32 v161, a77
    v_mul_f32 v161, v161, v157
    v_accvgpr_write_b32 a77, v161
    v_accvgpr_read_b32 v162, a78
    v_mul_f32 v162, v162, v157
    v_accvgpr_write_b32 a78, v162
    v_accvgpr_read_b32 v163, a79
    v_mul_f32 v163, v163, v157
    v_accvgpr_write_b32 a79, v163
    v_accvgpr_read_b32 v164, a92
    v_mul_f32 v164, v164, v157
    v_accvgpr_write_b32 a92, v164
    v_accvgpr_read_b32 v165, a93
    v_mul_f32 v165, v165, v157
    v_accvgpr_write_b32 a93, v165
    v_accvgpr_read_b32 v166, a94
    v_mul_f32 v166, v166, v157
    v_accvgpr_write_b32 a94, v166
    v_accvgpr_read_b32 v167, a95
    v_mul_f32 v167, v167, v157
    v_accvgpr_write_b32 a95, v167
    v_accvgpr_read_b32 v160, a108
    v_mul_f32 v160, v160, v157
    v_accvgpr_write_b32 a108, v160
    v_accvgpr_read_b32 v161, a109
    v_mul_f32 v161, v161, v157
    v_accvgpr_write_b32 a109, v161
    v_accvgpr_read_b32 v162, a110
    v_mul_f32 v162, v162, v157
    v_accvgpr_write_b32 a110, v162
    v_accvgpr_read_b32 v163, a111
    v_mul_f32 v163, v163, v157
    v_accvgpr_write_b32 a111, v163
    v_accvgpr_read_b32 v164, a124
    v_mul_f32 v164, v164, v157
    v_accvgpr_write_b32 a124, v164
    v_accvgpr_read_b32 v165, a125
    v_mul_f32 v165, v165, v157
    v_accvgpr_write_b32 a125, v165
    v_accvgpr_read_b32 v166, a126
    v_mul_f32 v166, v166, v157
    v_accvgpr_write_b32 a126, v166
    v_accvgpr_read_b32 v167, a127
    v_mul_f32 v167, v167, v157
    v_accvgpr_write_b32 a127, v167
    v_exp_f32 v128, v16
    v_exp_f32 v129, v17
    s_nop 0
    v_add_f32 v136, v128, v129
    v_cvt_pk_bf16_f32 v80, v128, v129
    v_exp_f32 v130, v18
    v_exp_f32 v131, v19
    v_add_f32 v136, v136, v130
    v_add_f32 v136, v136, v131
    v_cvt_pk_bf16_f32 v81, v130, v131
    v_exp_f32 v132, v20
    v_exp_f32 v133, v21
    s_nop 0
    v_add_f32 v137, v132, v133
    v_cvt_pk_bf16_f32 v84, v132, v133
    v_exp_f32 v134, v22
    v_exp_f32 v135, v23
    v_add_f32 v137, v137, v134
    v_add_f32 v137, v137, v135
    v_cvt_pk_bf16_f32 v85, v134, v135
    v_exp_f32 v128, v24
    v_exp_f32 v129, v25
    s_nop 0
    v_add_f32 v138, v128, v129
    v_cvt_pk_bf16_f32 v88, v128, v129
    v_exp_f32 v130, v26
    v_exp_f32 v131, v27
    v_add_f32 v138, v138, v130
    v_add_f32 v138, v138, v131
    v_cvt_pk_bf16_f32 v89, v130, v131
    v_exp_f32 v132, v28
    v_exp_f32 v133, v29
    s_nop 0
    v_add_f32 v139, v132, v133
    v_cvt_pk_bf16_f32 v92, v132, v133
    v_exp_f32 v134, v30
    v_exp_f32 v135, v31
    v_add_f32 v139, v139, v134
    v_add_f32 v139, v139, v135
    v_cvt_pk_bf16_f32 v93, v134, v135
    v_exp_f32 v128, v32
    v_exp_f32 v129, v33
    v_add_f32 v136, v136, v128
    v_add_f32 v136, v136, v129
    v_cvt_pk_bf16_f32 v82, v128, v129
    v_exp_f32 v130, v34
    v_exp_f32 v131, v35
    v_add_f32 v136, v136, v130
    v_add_f32 v136, v136, v131
    v_cvt_pk_bf16_f32 v83, v130, v131
    v_exp_f32 v132, v36
    v_exp_f32 v133, v37
    v_add_f32 v137, v137, v132
    v_add_f32 v137, v137, v133
    v_cvt_pk_bf16_f32 v86, v132, v133
    v_exp_f32 v134, v38
    v_exp_f32 v135, v39
    v_add_f32 v137, v137, v134
    v_add_f32 v137, v137, v135
    v_cvt_pk_bf16_f32 v87, v134, v135
    v_exp_f32 v128, v40
    v_exp_f32 v129, v41
    v_add_f32 v138, v138, v128
    v_add_f32 v138, v138, v129
    v_cvt_pk_bf16_f32 v90, v128, v129
    v_exp_f32 v130, v42
    v_exp_f32 v131, v43
    v_add_f32 v138, v138, v130
    v_add_f32 v138, v138, v131
    v_cvt_pk_bf16_f32 v91, v130, v131
    v_exp_f32 v132, v44
    v_exp_f32 v133, v45
    v_add_f32 v139, v139, v132
    v_add_f32 v139, v139, v133
    v_cvt_pk_bf16_f32 v94, v132, v133
    v_exp_f32 v134, v46
    v_exp_f32 v135, v47
    v_add_f32 v139, v139, v134
    v_add_f32 v139, v139, v135
    v_cvt_pk_bf16_f32 v95, v134, v135
    v_exp_f32 v128, v48
    s_nop 3
    s_setpc_b64 s[86:87]
L_slow_1:
    s_nop 15
    v_max3_f32 v150, v48, v49, v50
    v_max3_f32 v150, v150, v51, v64
    v_max3_f32 v150, v150, v65, v66
    v_max_f32 v150, v150, v67
    v_mov_b32 v158, v150
    s_nop 1
    v_permlane16_swap_b32 v150, v158
    v_max_f32 v150, v150, v158
    v_mov_b32 v158, v150
    s_nop 1
    v_permlane32_swap_b32 v150, v158
    v_max_f32 v150, v150, v158
    v_ceil_f32 v150, v150
    v_max_f32 v150, 0, v150
    v_exp_f32 v154, -v150
    v_max3_f32 v151, v52, v53, v54
    v_max3_f32 v151, v151, v55, v68
    v_max3_f32 v151, v151, v69, v70
    v_max_f32 v151, v151, v71
    v_mov_b32 v158, v151
    s_nop 1
    v_permlane16_swap_b32 v151, v158
    v_max_f32 v151, v151, v158
    v_mov_b32 v158, v151
    s_nop 1
    v_permlane32_swap_b32 v151, v158
    v_max_f32 v151, v151, v158
    v_ceil_f32 v151, v151
    v_max_f32 v151, 0, v151
    v_exp_f32 v155, -v151
    v_max3_f32 v152, v56, v57, v58
    v_max3_f32 v152, v152, v59, v72
    v_max3_f32 v152, v152, v73, v74
    v_max_f32 v152, v152, v75
    v_mov_b32 v158, v152
    s_nop 1
    v_permlane16_swap_b32 v152, v158
    v_max_f32 v152, v152, v158
    v_mov_b32 v158, v152
    s_nop 1
    v_permlane32_swap_b32 v152, v158
    v_max_f32 v152, v152, v158
    v_ceil_f32 v152, v152
    v_max_f32 v152, 0, v152
    v_exp_f32 v156, -v152
    v_max3_f32 v153, v60, v61, v62
    v_max3_f32 v153, v153, v63, v76
    v_max3_f32 v153, v153, v77, v78
    v_max_f32 v153, v153, v79
    v_mov_b32 v158, v153
    s_nop 1
    v_permlane16_swap_b32 v153, v158
    v_max_f32 v153, v153, v158
    v_mov_b32 v158, v153
    s_nop 1
    v_permlane32_swap_b32 v153, v158
    v_max_f32 v153, v153, v158
    v_ceil_f32 v153, v153
    v_max_f32 v153, 0, v153
    v_exp_f32 v157, -v153
    v_sub_f32 v112, v112, v150
    v_sub_f32 v113, v113, v150
    v_sub_f32 v114, v114, v150
    v_sub_f32 v115, v115, v150
    v_sub_f32 v48, v48, v150
    v_sub_f32 v49, v49, v150
    v_sub_f32 v50, v50, v150
    v_sub_f32 v51, v51, v150
    v_sub_f32 v64, v64, v150
    v_sub_f32 v65, v65, v150
    v_sub_f32 v66, v66, v150
    v_sub_f32 v67, v67, v150
    v_sub_f32 v16, v16, v150
    v_sub_f32 v17, v17, v150
    v_sub_f32 v18, v18, v150
    v_sub_f32 v19, v19, v150
    v_sub_f32 v32, v32, v150
    v_sub_f32 v33, v33, v150
    v_sub_f32 v34, v34, v150
    v_sub_f32 v35, v35, v150
    v_mul_f32 v144, v144, v154
    v_accvgpr_read_b32 v160, a0
    v_mul_f32 v160, v160, v154
    v_accvgpr_write_b32 a0, v160
    v_accvgpr_read_b32 v161, a1
    v_mul_f32 v161, v161, v154
    v_accvgpr_write_b32 a1, v161
    v_accvgpr_read_b32 v162, a2
    v_mul_f32 v162, v162, v154
    v_accvgpr_write_b32 a2, v162
    v_accvgpr_read_b32 v163, a3
    v_mul_f32 v163, v163, v154
    v_accvgpr_write_b32 a3, v163
    v_accvgpr_read_b32 v164, a16
    v_mul_f32 v164, v164, v154
    v_accvgpr_write_b32 a16, v164
    v_accvgpr_read_b32 v165, a17
    v_mul_f32 v165, v165, v154
    v_accvgpr_write_b32 a17, v165
    v_accvgpr_read_b32 v166, a18
    v_mul_f32 v166, v166, v154
    v_accvgpr_write_b32 a18, v166
    v_accvgpr_read_b32 v167, a19
    v_mul_f32 v167, v167, v154
    v_accvgpr_write_b32 a19, v167
    v_accvgpr_read_b32 v160, a32
    v_mul_f32 v160, v160, v154
    v_accvgpr_write_b32 a32, v160
    v_accvgpr_read_b32 v161, a33
    v_mul_f32 v161, v161, v154
    v_accvgpr_write_b32 a33, v161
    v_accvgpr_read_b32 v162, a34
    v_mul_f32 v162, v162, v154
    v_accvgpr_write_b32 a34, v162
    v_accvgpr_read_b32 v163, a35
    v_mul_f32 v163, v163, v154
    v_accvgpr_write_b32 a35, v163
    v_accvgpr_read_b32 v164, a48
    v_mul_f32 v164, v164, v154
    v_accvgpr_write_b32 a48, v164
    v_accvgpr_read_b32 v165, a49
    v_mul_f32 v165, v165, v154
    v_accvgpr_write_b32 a49, v165
    v_accvgpr_read_b32 v166, a50
    v_mul_f32 v166, v166, v154
    v_accvgpr_write_b32 a50, v166
    v_accvgpr_read_b32 v167, a51
    v_mul_f32 v167, v167, v154
    v_accvgpr_write_b32 a51, v167
    v_accvgpr_read_b32 v160, a64
    v_mul_f32 v160, v160, v154
    v_accvgpr_write_b32 a64, v160
    v_accvgpr_read_b32 v161, a65
    v_mul_f32 v161, v161, v154
    v_accvgpr_write_b32 a65, v161
    v_accvgpr_read_b32 v162, a66
    v_mul_f32 v162, v162, v154
    v_accvgpr_write_b32 a66, v162
    v_accvgpr_read_b32 v163, a67
    v_mul_f32 v163, v163, v154
    v_accvgpr_write_b32 a67, v163
    v_accvgpr_read_b32 v164, a80
    v_mul_f32 v164, v164, v154
    v_accvgpr_write_b32 a80, v164
    v_accvgpr_read_b32 v165, a81
    v_mul_f32 v165, v165, v154
    v_accvgpr_write_b32 a81, v165
    v_accvgpr_read_b32 v166, a82
    v_mul_f32 v166, v166, v154
    v_accvgpr_write_b32 a82, v166
    v_accvgpr_read_b32 v167, a83
    v_mul_f32 v167, v167, v154
    v_accvgpr_write_b32 a83, v167
    v_accvgpr_read_b32 v160, a96
    v_mul_f32 v160, v160, v154
    v_accvgpr_write_b32 a96, v160
    v_accvgpr_read_b32 v161, a97
    v_mul_f32 v161, v161, v154
    v_accvgpr_write_b32 a97, v161
    v_accvgpr_read_b32 v162, a98
    v_mul_f32 v162, v162, v154
    v_accvgpr_write_b32 a98, v162
    v_accvgpr_read_b32 v163, a99
    v_mul_f32 v163, v163, v154
    v_accvgpr_write_b32 a99, v163
    v_accvgpr_read_b32 v164, a112
    v_mul_f32 v164, v164, v154
    v_accvgpr_write_b32 a112, v164
    v_accvgpr_read_b32 v165, a113
    v_mul_f32 v165, v165, v154
    v_accvgpr_write_b32 a113, v165
    v_accvgpr_read_b32 v166, a114
    v_mul_f32 v166, v166, v154
    v_accvgpr_write_b32 a114, v166
    v_accvgpr_read_b32 v167, a115
    v_mul_f32 v167, v167, v154
    v_accvgpr_write_b32 a115, v167
    v_sub_f32 v116, v116, v151
    v_sub_f32 v117, v117, v151
    v_sub_f32 v118, v118, v151
    v_sub_f32 v119, v119, v151
    v_sub_f32 v52, v52, v151
    v_sub_f32 v53, v53, v151
    v_sub_f32 v54, v54, v151
    v_sub_f32 v55, v55, v151
    v_sub_f32 v68, v68, v151
    v_sub_f32 v69, v69, v151
    v_sub_f32 v70, v70, v151
    v_sub_f32 v71, v71, v151
    v_sub_f32 v20, v20, v151
    v_sub_f32 v21, v21, v151
    v_sub_f32 v22, v22, v151
    v_sub_f32 v23, v23, v151
    v_sub_f32 v36, v36, v151
    v_sub_f32 v37, v37, v151
    v_sub_f32 v38, v38, v151
    v_sub_f32 v39, v39, v151
    v_mul_f32 v145, v145, v155
    v_accvgpr_read_b32 v160, a4
    v_mul_f32 v160, v160, v155
    v_accvgpr_write_b32 a4, v160
    v_accvgpr_read_b32 v161, a5
    v_mul_f32 v161, v161, v155
    v_accvgpr_write_b32 a5, v161
    v_accvgpr_read_b32 v162, a6
    v_mul_f32 v162, v162, v155
    v_accvgpr_write_b32 a6, v162
    v_accvgpr_read_b32 v163, a7
    v_mul_f32 v163, v163, v155
    v_accvgpr_write_b32 a7, v163
    v_accvgpr_read_b32 v164, a20
    v_mul_f32 v164, v164, v155
    v_accvgpr_write_b32 a20, v164
    v_accvgpr_read_b32 v165, a21
    v_mul_f32 v165, v165, v155
    v_accvgpr_write_b32 a21, v165
    v_accvgpr_read_b32 v166, a22
    v_mul_f32 v166, v166, v155
    v_accvgpr_write_b32 a22, v166
    v_accvgpr_read_b32 v167, a23
    v_mul_f32 v167, v167, v155
    v_accvgpr_write_b32 a23, v167
    v_accvgpr_read_b32 v160, a36
    v_mul_f32 v160, v160, v155
    v_accvgpr_write_b32 a36, v160
    v_accvgpr_read_b32 v161, a37
    v_mul_f32 v161, v161, v155
    v_accvgpr_write_b32 a37, v161
    v_accvgpr_read_b32 v162, a38
    v_mul_f32 v162, v162, v155
    v_accvgpr_write_b32 a38, v162
    v_accvgpr_read_b32 v163, a39
    v_mul_f32 v163, v163, v155
    v_accvgpr_write_b32 a39, v163
    v_accvgpr_read_b32 v164, a52
    v_mul_f32 v164, v164, v155
    v_accvgpr_write_b32 a52, v164
    v_accvgpr_read_b32 v165, a53
    v_mul_f32 v165, v165, v155
    v_accvgpr_write_b32 a53, v165
    v_accvgpr_read_b32 v166, a54
    v_mul_f32 v166, v166, v155
    v_accvgpr_write_b32 a54, v166
    v_accvgpr_read_b32 v167, a55
    v_mul_f32 v167, v167, v155
    v_accvgpr_write_b32 a55, v167
    v_accvgpr_read_b32 v160, a68
    v_mul_f32 v160, v160, v155
    v_accvgpr_write_b32 a68, v160
    v_accvgpr_read_b32 v161, a69
    v_mul_f32 v161, v161, v155
    v_accvgpr_write_b32 a69, v161
    v_accvgpr_read_b32 v162, a70
    v_mul_f32 v162, v162, v155
    v_accvgpr_write_b32 a70, v162
    v_accvgpr_read_b32 v163, a71
    v_mul_f32 v163, v163, v155
    v_accvgpr_write_b32 a71, v163
    v_accvgpr_read_b32 v164, a84
    v_mul_f32 v164, v164, v155
    v_accvgpr_write_b32 a84, v164
    v_accvgpr_read_b32 v165, a85
    v_mul_f32 v165, v165, v155
    v_accvgpr_write_b32 a85, v165
    v_accvgpr_read_b32 v166, a86
    v_mul_f32 v166, v166, v155
    v_accvgpr_write_b32 a86, v166
    v_accvgpr_read_b32 v167, a87
    v_mul_f32 v167, v167, v155
    v_accvgpr_write_b32 a87, v167
    v_accvgpr_read_b32 v160, a100
    v_mul_f32 v160, v160, v155
    v_accvgpr_write_b32 a100, v160
    v_accvgpr_read_b32 v161, a101
    v_mul_f32 v161, v161, v155
    v_accvgpr_write_b32 a101, v161
    v_accvgpr_read_b32 v162, a102
    v_mul_f32 v162, v162, v155
    v_accvgpr_write_b32 a102, v162
    v_accvgpr_read_b32 v163, a103
    v_mul_f32 v163, v163, v155
    v_accvgpr_write_b32 a103, v163
    v_accvgpr_read_b32 v164, a116
    v_mul_f32 v164, v164, v155
    v_accvgpr_write_b32 a116, v164
    v_accvgpr_read_b32 v165, a117
    v_mul_f32 v165, v165, v155
    v_accvgpr_write_b32 a117, v165
    v_accvgpr_read_b32 v166, a118
    v_mul_f32 v166, v166, v155
    v_accvgpr_write_b32 a118, v166
    v_accvgpr_read_b32 v167, a119
    v_mul_f32 v167, v167, v155
    v_accvgpr_write_b32 a119, v167
    v_sub_f32 v120, v120, v152
    v_sub_f32 v121, v121, v152
    v_sub_f32 v122, v122, v152
    v_sub_f32 v123, v123, v152
    v_sub_f32 v56, v56, v152
    v_sub_f32 v57, v57, v152
    v_sub_f32 v58, v58, v152
    v_sub_f32 v59, v59, v152
    v_sub_f32 v72, v72, v152
    v_sub_f32 v73, v73, v152
    v_sub_f32 v74, v74, v152
    v_sub_f32 v75, v75, v152
    v_sub_f32 v24, v24, v152
    v_sub_f32 v25, v25, v152
    v_sub_f32 v26, v26, v152
    v_sub_f32 v27, v27, v152
    v_sub_f32 v40, v40, v152
    v_sub_f32 v41, v41, v152
    v_sub_f32 v42, v42, v152
    v_sub_f32 v43, v43, v152
    v_mul_f32 v146, v146, v156
    v_accvgpr_read_b32 v160, a8
    v_mul_f32 v160, v160, v156
    v_accvgpr_write_b32 a8, v160
    v_accvgpr_read_b32 v161, a9
    v_mul_f32 v161, v161, v156
    v_accvgpr_write_b32 a9, v161
    v_accvgpr_read_b32 v162, a10
    v_mul_f32 v162, v162, v156
    v_accvgpr_write_b32 a10, v162
    v_accvgpr_read_b32 v163, a11
    v_mul_f32 v163, v163, v156
    v_accvgpr_write_b32 a11, v163
    v_accvgpr_read_b32 v164, a24
    v_mul_f32 v164, v164, v156
    v_accvgpr_write_b32 a24, v164
    v_accvgpr_read_b32 v165, a25
    v_mul_f32 v165, v165, v156
    v_accvgpr_write_b32 a25, v165
    v_accvgpr_read_b32 v166, a26
    v_mul_f32 v166, v166, v156
    v_accvgpr_write_b32 a26, v166
    v_accvgpr_read_b32 v167, a27
    v_mul_f32 v167, v167, v156
    v_accvgpr_write_b32 a27, v167
    v_accvgpr_read_b32 v160, a40
    v_mul_f32 v160, v160, v156
    v_accvgpr_write_b32 a40, v160
    v_accvgpr_read_b32 v161, a41
    v_mul_f32 v161, v161, v156
    v_accvgpr_write_b32 a41, v161
    v_accvgpr_read_b32 v162, a42
    v_mul_f32 v162, v162, v156
    v_accvgpr_write_b32 a42, v162
    v_accvgpr_read_b32 v163, a43
    v_mul_f32 v163, v163, v156
    v_accvgpr_write_b32 a43, v163
    v_accvgpr_read_b32 v164, a56
    v_mul_f32 v164, v164, v156
    v_accvgpr_write_b32 a56, v164
    v_accvgpr_read_b32 v165, a57
    v_mul_f32 v165, v165, v156
    v_accvgpr_write_b32 a57, v165
    v_accvgpr_read_b32 v166, a58
    v_mul_f32 v166, v166, v156
    v_accvgpr_write_b32 a58, v166
    v_accvgpr_read_b32 v167, a59
    v_mul_f32 v167, v167, v156
    v_accvgpr_write_b32 a59, v167
    v_accvgpr_read_b32 v160, a72
    v_mul_f32 v160, v160, v156
    v_accvgpr_write_b32 a72, v160
    v_accvgpr_read_b32 v161, a73
    v_mul_f32 v161, v161, v156
    v_accvgpr_write_b32 a73, v161
    v_accvgpr_read_b32 v162, a74
    v_mul_f32 v162, v162, v156
    v_accvgpr_write_b32 a74, v162
    v_accvgpr_read_b32 v163, a75
    v_mul_f32 v163, v163, v156
    v_accvgpr_write_b32 a75, v163
    v_accvgpr_read_b32 v164, a88
    v_mul_f32 v164, v164, v156
    v_accvgpr_write_b32 a88, v164
    v_accvgpr_read_b32 v165, a89
    v_mul_f32 v165, v165, v156
    v_accvgpr_write_b32 a89, v165
    v_accvgpr_read_b32 v166, a90
    v_mul_f32 v166, v166, v156
    v_accvgpr_write_b32 a90, v166
    v_accvgpr_read_b32 v167, a91
    v_mul_f32 v167, v167, v156
    v_accvgpr_write_b32 a91, v167
    v_accvgpr_read_b32 v160, a104
    v_mul_f32 v160, v160, v156
    v_accvgpr_write_b32 a104, v160
    v_accvgpr_read_b32 v161, a105
    v_mul_f32 v161, v161, v156
    v_accvgpr_write_b32 a105, v161
    v_accvgpr_read_b32 v162, a106
    v_mul_f32 v162, v162, v156
    v_accvgpr_write_b32 a106, v162
    v_accvgpr_read_b32 v163, a107
    v_mul_f32 v163, v163, v156
    v_accvgpr_write_b32 a107, v163
    v_accvgpr_read_b32 v164, a120
    v_mul_f32 v164, v164, v156
    v_accvgpr_write_b32 a120, v164
    v_accvgpr_read_b32 v165, a121
    v_mul_f32 v165, v165, v156
    v_accvgpr_write_b32 a121, v165
    v_accvgpr_read_b32 v166, a122
    v_mul_f32 v166, v166, v156
    v_accvgpr_write_b32 a122, v166
    v_accvgpr_read_b32 v167, a123
    v_mul_f32 v167, v167, v156
    v_accvgpr_write_b32 a123, v167
    v_sub_f32 v124, v124, v153
    v_sub_f32 v125, v125, v153
    v_sub_f32 v126, v126, v153
    v_sub_f32 v127, v127, v153
    v_sub_f32 v60, v60, v153
    v_sub_f32 v61, v61, v153
    v_sub_f32 v62, v62, v153
    v_sub_f32 v63, v63, v153
    v_sub_f32 v76, v76, v153
    v_sub_f32 v77, v77, v153
    v_sub_f32 v78, v78, v153
    v_sub_f32 v79, v79, v153
    v_sub_f32 v28, v28, v153
    v_sub_f32 v29, v29, v153
    v_sub_f32 v30, v30, v153
    v_sub_f32 v31, v31, v153
    v_sub_f32 v44, v44, v153
    v_sub_f32 v45, v45, v153
    v_sub_f32 v46, v46, v153
    v_sub_f32 v47, v47, v153
    v_mul_f32 v147, v147, v157
    v_accvgpr_read_b32 v160, a12
    v_mul_f32 v160, v160, v157
    v_accvgpr_write_b32 a12, v160
    v_accvgpr_read_b32 v161, a13
    v_mul_f32 v161, v161, v157
    v_accvgpr_write_b32 a13, v161
    v_accvgpr_read_b32 v162, a14
    v_mul_f32 v162, v162, v157
    v_accvgpr_write_b32 a14, v162
    v_accvgpr_read_b32 v163, a15
    v_mul_f32 v163, v163, v157
    v_accvgpr_write_b32 a15, v163
    v_accvgpr_read_b32 v164, a28
    v_mul_f32 v164, v164, v157
    v_accvgpr_write_b32 a28, v164
    v_accvgpr_read_b32 v165, a29
    v_mul_f32 v165, v165, v157
    v_accvgpr_write_b32 a29, v165
    v_accvgpr_read_b32 v166, a30
    v_mul_f32 v166, v166, v157
    v_accvgpr_write_b32 a30, v166
    v_accvgpr_read_b32 v167, a31
    v_mul_f32 v167, v167, v157
    v_accvgpr_write_b32 a31, v167
    v_accvgpr_read_b32 v160, a44
    v_mul_f32 v160, v160, v157
    v_accvgpr_write_b32 a44, v160
    v_accvgpr_read_b32 v161, a45
    v_mul_f32 v161, v161, v157
    v_accvgpr_write_b32 a45, v161
    v_accvgpr_read_b32 v162, a46
    v_mul_f32 v162, v162, v157
    v_accvgpr_write_b32 a46, v162
    v_accvgpr_read_b32 v163, a47
    v_mul_f32 v163, v163, v157
    v_accvgpr_write_b32 a47, v163
    v_accvgpr_read_b32 v164, a60
    v_mul_f32 v164, v164, v157
    v_accvgpr_write_b32 a60, v164
    v_accvgpr_read_b32 v165, a61
    v_mul_f32 v165, v165, v157
    v_accvgpr_write_b32 a61, v165
    v_accvgpr_read_b32 v166, a62
    v_mul_f32 v166, v166, v157
    v_accvgpr_write_b32 a62, v166
    v_accvgpr_read_b32 v167, a63
    v_mul_f32 v167, v167, v157
    v_accvgpr_write_b32 a63, v167
    v_accvgpr_read_b32 v160, a76
    v_mul_f32 v160, v160, v157
    v_accvgpr_write_b32 a76, v160
    v_accvgpr_read_b32 v161, a77
    v_mul_f32 v161, v161, v157
    v_accvgpr_write_b32 a77, v161
    v_accvgpr_read_b32 v162, a78
    v_mul_f32 v162, v162, v157
    v_accvgpr_write_b32 a78, v162
    v_accvgpr_read_b32 v163, a79
    v_mul_f32 v163, v163, v157
    v_accvgpr_write_b32 a79, v163
    v_accvgpr_read_b32 v164, a92
    v_mul_f32 v164, v164, v157
    v_accvgpr_write_b32 a92, v164
    v_accvgpr_read_b32 v165, a93
    v_mul_f32 v165, v165, v157
    v_accvgpr_write_b32 a93, v165
    v_accvgpr_read_b32 v166, a94
    v_mul_f32 v166, v166, v157
    v_accvgpr_write_b32 a94, v166
    v_accvgpr_read_b32 v167, a95
    v_mul_f32 v167, v167, v157
    v_accvgpr_write_b32 a95, v167
    v_accvgpr_read_b32 v160, a108
    v_mul_f32 v160, v160, v157
    v_accvgpr_write_b32 a108, v160
    v_accvgpr_read_b32 v161, a109
    v_mul_f32 v161, v161, v157
    v_accvgpr_write_b32 a109, v161
    v_accvgpr_read_b32 v162, a110
    v_mul_f32 v162, v162, v157
    v_accvgpr_write_b32 a110, v162
    v_accvgpr_read_b32 v163, a111
    v_mul_f32 v163, v163, v157
    v_accvgpr_write_b32 a111, v163
    v_accvgpr_read_b32 v164, a124
    v_mul_f32 v164, v164, v157
    v_accvgpr_write_b32 a124, v164
    v_accvgpr_read_b32 v165, a125
    v_mul_f32 v165, v165, v157
    v_accvgpr_write_b32 a125, v165
    v_accvgpr_read_b32 v166, a126
    v_mul_f32 v166, v166, v157
    v_accvgpr_write_b32 a126, v166
    v_accvgpr_read_b32 v167, a127
    v_mul_f32 v167, v167, v157
    v_accvgpr_write_b32 a127, v167
    v_exp_f32 v128, v48
    v_exp_f32 v129, v49
    s_nop 0
    v_add_f32 v140, v128, v129
    v_cvt_pk_bf16_f32 v96, v128, v129
    v_exp_f32 v130, v50
    v_exp_f32 v131, v51
    v_add_f32 v140, v140, v130
    v_add_f32 v140, v140, v131
    v_cvt_pk_bf16_f32 v97, v130, v131
    v_exp_f32 v132, v52
    v_exp_f32 v133, v53
    s_nop 0
    v_add_f32 v141, v132, v133
    v_cvt_pk_bf16_f32 v100, v132, v133
    v_exp_f32 v134, v54
    v_exp_f32 v135, v55
    v_add_f32 v141, v141, v134
    v_add_f32 v141, v141, v135
    v_cvt_pk_bf16_f32 v101, v134, v135
    v_exp_f32 v128, v56
    v_exp_f32 v129, v57
    s_nop 0
    v_add_f32 v142, v128, v129
    v_cvt_pk_bf16_f32 v104, v128, v129
    v_exp_f32 v130, v58
    v_exp_f32 v131, v59
    v_add_f32 v142, v142, v130
    v_add_f32 v142, v142, v131
    v_cvt_pk_bf16_f32 v105, v130, v131
    v_exp_f32 v132, v60
    v_exp_f32 v133, v61
    s_nop 0
    v_add_f32 v143, v132, v133
    v_cvt_pk_bf16_f32 v108, v132, v133
    v_exp_f32 v134, v62
    v_exp_f32 v135, v63
    v_add_f32 v143, v143, v134
    v_add_f32 v143, v143, v135
    v_cvt_pk_bf16_f32 v109, v134, v135
    v_exp_f32 v128, v64
    v_exp_f32 v129, v65
    v_add_f32 v140, v140, v128
    v_add_f32 v140, v140, v129
    v_cvt_pk_bf16_f32 v98, v128, v129
    v_exp_f32 v130, v66
    v_exp_f32 v131, v67
    v_add_f32 v140, v140, v130
    v_add_f32 v140, v140, v131
    v_cvt_pk_bf16_f32 v99, v130, v131
    v_exp_f32 v132, v68
    v_exp_f32 v133, v69
    v_add_f32 v141, v141, v132
    v_add_f32 v141, v141, v133
    v_cvt_pk_bf16_f32 v102, v132, v133
    v_exp_f32 v134, v70
    v_exp_f32 v135, v71
    v_add_f32 v141, v141, v134
    v_add_f32 v141, v141, v135
    v_cvt_pk_bf16_f32 v103, v134, v135
    v_exp_f32 v128, v72
    v_exp_f32 v129, v73
    v_add_f32 v142, v142, v128
    v_add_f32 v142, v142, v129
    v_cvt_pk_bf16_f32 v106, v128, v129
    v_exp_f32 v130, v74
    v_exp_f32 v131, v75
    v_add_f32 v142, v142, v130
    v_add_f32 v142, v142, v131
    v_cvt_pk_bf16_f32 v107, v130, v131
    v_exp_f32 v132, v76
    v_exp_f32 v133, v77
    v_add_f32 v143, v143, v132
    v_add_f32 v143, v143, v133
    v_cvt_pk_bf16_f32 v110, v132, v133
    v_exp_f32 v134, v78
    v_exp_f32 v135, v79
    v_add_f32 v143, v143, v134
    v_add_f32 v143, v143, v135
    v_cvt_pk_bf16_f32 v111, v134, v135
    v_exp_f32 v128, v16
    s_nop 3
    s_setpc_b64 s[86:87]
L_fb:
    s_not_b32 s75, s17
    s_ff1_i32_b32 s74, s75
    s_bitset1_b32 s17, s74
    s_call_b64 s[84:85], L_deq
    s_nop 3
    s_cmp_lg_u32 s17, -1
    s_cbranch_scc1 L_fb
    s_waitcnt vmcnt(0)
    s_barrier
    s_branch L_ready
L_deq:
    v_mov_b32 v228, 0x3e0293ee
    v_mov_b32 v229, 0x3e0293ee
    s_lshl_b32 s75, s72, 11
    s_lshl_b32 s76, s74, 6
    s_add_u32 s75, s75, s76
    s_lshl_b32 s76, s72, 5
    s_add_u32 s76, s76, s74
    s_lshl_b32 s76, s76, 8
    s_lshl_b32 s77, s16, 6
    s_add_u32 s76, s76, s77
    s_lshr_b32 s77, s16, 1
    s_lshl_b32 s77, s77, 5
    s_add_u32 s77, s77, s75
    s_lshl_b32 s79, s77, 9
    s_lshl_b32 s77, s77, 1
    s_and_b32 s78, s16, 1
    s_lshl_b32 s78, s78, 8
    s_add_u32 s79, s79, s78
    s_lshl_b32 s78, s75, 9
    s_lshl_b32 s80, s16, 7
    s_add_u32 s78, s78, s80
    s_lshl_b32 s81, s72, 19
    s_lshl_b32 s80, s74, 14
    s_add_u32 s81, s81, s80
    s_lshl_b32 s80, s16, 12
    s_add_u32 s82, s81, s80
    s_add_u32 s82, s82, 4194304
    s_lshl_b32 s80, s16, 10
    s_add_u32 s81, s81, s80
    buffer_load_dwordx4 v[200:203], v8, s[52:55], s76 offen
    buffer_load_dwordx4 v[204:207], v8, s[56:59], s76 offen
    buffer_load_dwordx4 v[168:171], v6, s[44:47], s78 offen offset:0 nt
    buffer_load_dwordx4 v[172:175], v6, s[44:47], s78 offen offset:16 nt
    s_add_u32 s78, s78, 8192
    buffer_load_dwordx4 v[176:179], v6, s[44:47], s78 offen offset:0 nt
    buffer_load_dwordx4 v[180:183], v6, s[44:47], s78 offen offset:16 nt
    s_add_u32 s78, s78, 8192
    buffer_load_dwordx4 v[184:187], v6, s[44:47], s78 offen offset:0 nt
    buffer_load_dwordx4 v[188:191], v6, s[44:47], s78 offen offset:16 nt
    s_add_u32 s78, s78, 8192
    buffer_load_dwordx4 v[192:195], v6, s[44:47], s78 offen offset:0 nt
    buffer_load_dwordx4 v[196:199], v6, s[44:47], s78 offen offset:16 nt
    s_waitcnt vmcnt(8)
    v_lshlrev_b32 v208, 16, v200
    v_and_b32 v209, 0xffff0000, v200
    v_lshlrev_b32 v210, 16, v201
    v_and_b32 v211, 0xffff0000, v201
    v_lshlrev_b32 v212, 16, v202
    v_and_b32 v213, 0xffff0000, v202
    v_lshlrev_b32 v214, 16, v203
    v_and_b32 v215, 0xffff0000, v203
    v_lshlrev_b32 v216, 16, v204
    v_and_b32 v217, 0xffff0000, v204
    v_lshlrev_b32 v218, 16, v205
    v_and_b32 v219, 0xffff0000, v205
    v_lshlrev_b32 v220, 16, v206
    v_and_b32 v221, 0xffff0000, v206
    v_lshlrev_b32 v222, 16, v207
    v_and_b32 v223, 0xffff0000, v207
    s_waitcnt vmcnt(6)
    v_cvt_f32_i32 v168, v168
    v_cvt_f32_i32 v169, v169
    v_cvt_f32_i32 v170, v170
    v_cvt_f32_i32 v171, v171
    v_cvt_f32_i32 v172, v172
    v_cvt_f32_i32 v173, v173
    v_cvt_f32_i32 v174, v174
    v_cvt_f32_i32 v175, v175
    v_cvt_pk_bf16_f32 v224, v168, v169
    v_cvt_pk_bf16_f32 v225, v170, v171
    v_cvt_pk_bf16_f32 v226, v172, v173
    v_cvt_pk_bf16_f32 v227, v174, v175
    v_lshlrev_b32 v168, 16, v224
    v_and_b32 v169, 0xffff0000, v224
    v_lshlrev_b32 v170, 16, v225
    v_and_b32 v171, 0xffff0000, v225
    v_lshlrev_b32 v172, 16, v226
    v_and_b32 v173, 0xffff0000, v226
    v_lshlrev_b32 v174, 16, v227
    v_and_b32 v175, 0xffff0000, v227
    v_pk_add_f32 v[168:169], v[168:169], v[216:217] neg_lo:[0,1] neg_hi:[0,1]
    v_pk_add_f32 v[170:171], v[170:171], v[218:219] neg_lo:[0,1] neg_hi:[0,1]
    v_pk_add_f32 v[172:173], v[172:173], v[220:221] neg_lo:[0,1] neg_hi:[0,1]
    v_pk_add_f32 v[174:175], v[174:175], v[222:223] neg_lo:[0,1] neg_hi:[0,1]
    v_cvt_pk_bf16_f32 v224, v168, v169
    v_cvt_pk_bf16_f32 v225, v170, v171
    v_cvt_pk_bf16_f32 v226, v172, v173
    v_cvt_pk_bf16_f32 v227, v174, v175
    v_lshlrev_b32 v168, 16, v224
    v_and_b32 v169, 0xffff0000, v224
    v_lshlrev_b32 v170, 16, v225
    v_and_b32 v171, 0xffff0000, v225
    v_lshlrev_b32 v172, 16, v226
    v_and_b32 v173, 0xffff0000, v226
    v_lshlrev_b32 v174, 16, v227
    v_and_b32 v175, 0xffff0000, v227
    v_pk_mul_f32 v[168:169], v[168:169], v[208:209]
    v_pk_mul_f32 v[170:171], v[170:171], v[210:211]
    v_pk_mul_f32 v[172:173], v[172:173], v[212:213]
    v_pk_mul_f32 v[174:175], v[174:175], v[214:215]
    v_cvt_pk_bf16_f32 v224, v168, v169
    v_cvt_pk_bf16_f32 v225, v170, v171
    v_cvt_pk_bf16_f32 v226, v172, v173
    v_cvt_pk_bf16_f32 v227, v174, v175
    v_lshlrev_b32 v168, 16, v224
    v_and_b32 v169, 0xffff0000, v224
    v_lshlrev_b32 v170, 16, v225
    v_and_b32 v171, 0xffff0000, v225
    v_lshlrev_b32 v172, 16, v226
    v_and_b32 v173, 0xffff0000, v226
    v_lshlrev_b32 v174, 16, v227
    v_and_b32 v175, 0xffff0000, v227
    v_pk_mul_f32 v[168:169], v[168:169], v[228:229]
    v_pk_mul_f32 v[170:171], v[170:171], v[228:229]
    v_pk_mul_f32 v[172:173], v[172:173], v[228:229]
    v_pk_mul_f32 v[174:175], v[174:175], v[228:229]
    v_cvt_pk_bf16_f32 v232, v168, v169
    v_cvt_pk_bf16_f32 v233, v170, v171
    v_cvt_pk_bf16_f32 v234, v172, v173
    v_cvt_pk_bf16_f32 v235, v174, v175
    buffer_store_dwordx4 v[232:235], v1, s[8:11], s81 offen sc1
    s_add_u32 s81, s81, 4096
    s_waitcnt vmcnt(5)
    v_cvt_f32_i32 v176, v176
    v_cvt_f32_i32 v177, v177
    v_cvt_f32_i32 v178, v178
    v_cvt_f32_i32 v179, v179
    v_cvt_f32_i32 v180, v180
    v_cvt_f32_i32 v181, v181
    v_cvt_f32_i32 v182, v182
    v_cvt_f32_i32 v183, v183
    v_cvt_pk_bf16_f32 v224, v176, v177
    v_cvt_pk_bf16_f32 v225, v178, v179
    v_cvt_pk_bf16_f32 v226, v180, v181
    v_cvt_pk_bf16_f32 v227, v182, v183
    v_lshlrev_b32 v176, 16, v224
    v_and_b32 v177, 0xffff0000, v224
    v_lshlrev_b32 v178, 16, v225
    v_and_b32 v179, 0xffff0000, v225
    v_lshlrev_b32 v180, 16, v226
    v_and_b32 v181, 0xffff0000, v226
    v_lshlrev_b32 v182, 16, v227
    v_and_b32 v183, 0xffff0000, v227
    v_pk_add_f32 v[176:177], v[176:177], v[216:217] neg_lo:[0,1] neg_hi:[0,1]
    v_pk_add_f32 v[178:179], v[178:179], v[218:219] neg_lo:[0,1] neg_hi:[0,1]
    v_pk_add_f32 v[180:181], v[180:181], v[220:221] neg_lo:[0,1] neg_hi:[0,1]
    v_pk_add_f32 v[182:183], v[182:183], v[222:223] neg_lo:[0,1] neg_hi:[0,1]
    v_cvt_pk_bf16_f32 v224, v176, v177
    v_cvt_pk_bf16_f32 v225, v178, v179
    v_cvt_pk_bf16_f32 v226, v180, v181
    v_cvt_pk_bf16_f32 v227, v182, v183
    v_lshlrev_b32 v176, 16, v224
    v_and_b32 v177, 0xffff0000, v224
    v_lshlrev_b32 v178, 16, v225
    v_and_b32 v179, 0xffff0000, v225
    v_lshlrev_b32 v180, 16, v226
    v_and_b32 v181, 0xffff0000, v226
    v_lshlrev_b32 v182, 16, v227
    v_and_b32 v183, 0xffff0000, v227
    v_pk_mul_f32 v[176:177], v[176:177], v[208:209]
    v_pk_mul_f32 v[178:179], v[178:179], v[210:211]
    v_pk_mul_f32 v[180:181], v[180:181], v[212:213]
    v_pk_mul_f32 v[182:183], v[182:183], v[214:215]
    v_cvt_pk_bf16_f32 v224, v176, v177
    v_cvt_pk_bf16_f32 v225, v178, v179
    v_cvt_pk_bf16_f32 v226, v180, v181
    v_cvt_pk_bf16_f32 v227, v182, v183
    v_lshlrev_b32 v176, 16, v224
    v_and_b32 v177, 0xffff0000, v224
    v_lshlrev_b32 v178, 16, v225
    v_and_b32 v179, 0xffff0000, v225
    v_lshlrev_b32 v180, 16, v226
    v_and_b32 v181, 0xffff0000, v226
    v_lshlrev_b32 v182, 16, v227
    v_and_b32 v183, 0xffff0000, v227
    v_pk_mul_f32 v[176:177], v[176:177], v[228:229]
    v_pk_mul_f32 v[178:179], v[178:179], v[228:229]
    v_pk_mul_f32 v[180:181], v[180:181], v[228:229]
    v_pk_mul_f32 v[182:183], v[182:183], v[228:229]
    v_cvt_pk_bf16_f32 v236, v176, v177
    v_cvt_pk_bf16_f32 v237, v178, v179
    v_cvt_pk_bf16_f32 v238, v180, v181
    v_cvt_pk_bf16_f32 v239, v182, v183
    buffer_store_dwordx4 v[236:239], v1, s[8:11], s81 offen sc1
    s_add_u32 s81, s81, 4096
    s_waitcnt vmcnt(4)
    v_cvt_f32_i32 v184, v184
    v_cvt_f32_i32 v185, v185
    v_cvt_f32_i32 v186, v186
    v_cvt_f32_i32 v187, v187
    v_cvt_f32_i32 v188, v188
    v_cvt_f32_i32 v189, v189
    v_cvt_f32_i32 v190, v190
    v_cvt_f32_i32 v191, v191
    v_cvt_pk_bf16_f32 v224, v184, v185
    v_cvt_pk_bf16_f32 v225, v186, v187
    v_cvt_pk_bf16_f32 v226, v188, v189
    v_cvt_pk_bf16_f32 v227, v190, v191
    v_lshlrev_b32 v184, 16, v224
    v_and_b32 v185, 0xffff0000, v224
    v_lshlrev_b32 v186, 16, v225
    v_and_b32 v187, 0xffff0000, v225
    v_lshlrev_b32 v188, 16, v226
    v_and_b32 v189, 0xffff0000, v226
    v_lshlrev_b32 v190, 16, v227
    v_and_b32 v191, 0xffff0000, v227
    v_pk_add_f32 v[184:185], v[184:185], v[216:217] neg_lo:[0,1] neg_hi:[0,1]
    v_pk_add_f32 v[186:187], v[186:187], v[218:219] neg_lo:[0,1] neg_hi:[0,1]
    v_pk_add_f32 v[188:189], v[188:189], v[220:221] neg_lo:[0,1] neg_hi:[0,1]
    v_pk_add_f32 v[190:191], v[190:191], v[222:223] neg_lo:[0,1] neg_hi:[0,1]
    v_cvt_pk_bf16_f32 v224, v184, v185
    v_cvt_pk_bf16_f32 v225, v186, v187
    v_cvt_pk_bf16_f32 v226, v188, v189
    v_cvt_pk_bf16_f32 v227, v190, v191
    v_lshlrev_b32 v184, 16, v224
    v_and_b32 v185, 0xffff0000, v224
    v_lshlrev_b32 v186, 16, v225
    v_and_b32 v187, 0xffff0000, v225
    v_lshlrev_b32 v188, 16, v226
    v_and_b32 v189, 0xffff0000, v226
    v_lshlrev_b32 v190, 16, v227
    v_and_b32 v191, 0xffff0000, v227
    v_pk_mul_f32 v[184:185], v[184:185], v[208:209]
    v_pk_mul_f32 v[186:187], v[186:187], v[210:211]
    v_pk_mul_f32 v[188:189], v[188:189], v[212:213]
    v_pk_mul_f32 v[190:191], v[190:191], v[214:215]
    v_cvt_pk_bf16_f32 v224, v184, v185
    v_cvt_pk_bf16_f32 v225, v186, v187
    v_cvt_pk_bf16_f32 v226, v188, v189
    v_cvt_pk_bf16_f32 v227, v190, v191
    v_lshlrev_b32 v184, 16, v224
    v_and_b32 v185, 0xffff0000, v224
    v_lshlrev_b32 v186, 16, v225
    v_and_b32 v187, 0xffff0000, v225
    v_lshlrev_b32 v188, 16, v226
    v_and_b32 v189, 0xffff0000, v226
    v_lshlrev_b32 v190, 16, v227
    v_and_b32 v191, 0xffff0000, v227
    v_pk_mul_f32 v[184:185], v[184:185], v[228:229]
    v_pk_mul_f32 v[186:187], v[186:187], v[228:229]
    v_pk_mul_f32 v[188:189], v[188:189], v[228:229]
    v_pk_mul_f32 v[190:191], v[190:191], v[228:229]
    v_cvt_pk_bf16_f32 v240, v184, v185
    v_cvt_pk_bf16_f32 v241, v186, v187
    v_cvt_pk_bf16_f32 v242, v188, v189
    v_cvt_pk_bf16_f32 v243, v190, v191
    buffer_store_dwordx4 v[240:243], v1, s[8:11], s81 offen sc1
    s_add_u32 s81, s81, 4096
    s_waitcnt vmcnt(3)
    v_cvt_f32_i32 v192, v192
    v_cvt_f32_i32 v193, v193
    v_cvt_f32_i32 v194, v194
    v_cvt_f32_i32 v195, v195
    v_cvt_f32_i32 v196, v196
    v_cvt_f32_i32 v197, v197
    v_cvt_f32_i32 v198, v198
    v_cvt_f32_i32 v199, v199
    v_cvt_pk_bf16_f32 v224, v192, v193
    v_cvt_pk_bf16_f32 v225, v194, v195
    v_cvt_pk_bf16_f32 v226, v196, v197
    v_cvt_pk_bf16_f32 v227, v198, v199
    v_lshlrev_b32 v192, 16, v224
    v_and_b32 v193, 0xffff0000, v224
    v_lshlrev_b32 v194, 16, v225
    v_and_b32 v195, 0xffff0000, v225
    v_lshlrev_b32 v196, 16, v226
    v_and_b32 v197, 0xffff0000, v226
    v_lshlrev_b32 v198, 16, v227
    v_and_b32 v199, 0xffff0000, v227
    v_pk_add_f32 v[192:193], v[192:193], v[216:217] neg_lo:[0,1] neg_hi:[0,1]
    v_pk_add_f32 v[194:195], v[194:195], v[218:219] neg_lo:[0,1] neg_hi:[0,1]
    v_pk_add_f32 v[196:197], v[196:197], v[220:221] neg_lo:[0,1] neg_hi:[0,1]
    v_pk_add_f32 v[198:199], v[198:199], v[222:223] neg_lo:[0,1] neg_hi:[0,1]
    v_cvt_pk_bf16_f32 v224, v192, v193
    v_cvt_pk_bf16_f32 v225, v194, v195
    v_cvt_pk_bf16_f32 v226, v196, v197
    v_cvt_pk_bf16_f32 v227, v198, v199
    v_lshlrev_b32 v192, 16, v224
    v_and_b32 v193, 0xffff0000, v224
    v_lshlrev_b32 v194, 16, v225
    v_and_b32 v195, 0xffff0000, v225
    v_lshlrev_b32 v196, 16, v226
    v_and_b32 v197, 0xffff0000, v226
    v_lshlrev_b32 v198, 16, v227
    v_and_b32 v199, 0xffff0000, v227
    v_pk_mul_f32 v[192:193], v[192:193], v[208:209]
    v_pk_mul_f32 v[194:195], v[194:195], v[210:211]
    v_pk_mul_f32 v[196:197], v[196:197], v[212:213]
    v_pk_mul_f32 v[198:199], v[198:199], v[214:215]
    v_cvt_pk_bf16_f32 v224, v192, v193
    v_cvt_pk_bf16_f32 v225, v194, v195
    v_cvt_pk_bf16_f32 v226, v196, v197
    v_cvt_pk_bf16_f32 v227, v198, v199
    v_lshlrev_b32 v192, 16, v224
    v_and_b32 v193, 0xffff0000, v224
    v_lshlrev_b32 v194, 16, v225
    v_and_b32 v195, 0xffff0000, v225
    v_lshlrev_b32 v196, 16, v226
    v_and_b32 v197, 0xffff0000, v226
    v_lshlrev_b32 v198, 16, v227
    v_and_b32 v199, 0xffff0000, v227
    v_pk_mul_f32 v[192:193], v[192:193], v[228:229]
    v_pk_mul_f32 v[194:195], v[194:195], v[228:229]
    v_pk_mul_f32 v[196:197], v[196:197], v[228:229]
    v_pk_mul_f32 v[198:199], v[198:199], v[228:229]
    v_cvt_pk_bf16_f32 v244, v192, v193
    v_cvt_pk_bf16_f32 v245, v194, v195
    v_cvt_pk_bf16_f32 v246, v196, v197
    v_cvt_pk_bf16_f32 v247, v198, v199
    buffer_store_dwordx4 v[244:247], v1, s[8:11], s81 offen sc1
    s_waitcnt vmcnt(0)
    buffer_load_dwordx2 v[200:201], v9, s[60:63], s77 offen offset:0
    buffer_load_dwordx2 v[202:203], v9, s[60:63], s77 offen offset:32
    buffer_load_dwordx2 v[204:205], v9, s[64:67], s77 offen offset:0
    buffer_load_dwordx2 v[206:207], v9, s[64:67], s77 offen offset:32
    buffer_load_dwordx4 v[168:171], v7, s[48:51], s79 offen offset:0 nt
    buffer_load_dwordx4 v[172:175], v7, s[48:51], s79 offen offset:512 nt
    buffer_load_dwordx4 v[176:179], v7, s[48:51], s79 offen offset:1024 nt
    buffer_load_dwordx4 v[180:183], v7, s[48:51], s79 offen offset:1536 nt
    s_add_u32 s79, s79, 8192
    buffer_load_dwordx4 v[184:187], v7, s[48:51], s79 offen offset:0 nt
    buffer_load_dwordx4 v[188:191], v7, s[48:51], s79 offen offset:512 nt
    buffer_load_dwordx4 v[192:195], v7, s[48:51], s79 offen offset:1024 nt
    buffer_load_dwordx4 v[196:199], v7, s[48:51], s79 offen offset:1536 nt
    s_waitcnt vmcnt(8)
    v_lshlrev_b32 v208, 16, v200
    v_and_b32 v209, 0xffff0000, v200
    v_lshlrev_b32 v210, 16, v201
    v_and_b32 v211, 0xffff0000, v201
    v_lshlrev_b32 v212, 16, v202
    v_and_b32 v213, 0xffff0000, v202
    v_lshlrev_b32 v214, 16, v203
    v_and_b32 v215, 0xffff0000, v203
    v_lshlrev_b32 v216, 16, v204
    v_and_b32 v217, 0xffff0000, v204
    v_lshlrev_b32 v218, 16, v205
    v_and_b32 v219, 0xffff0000, v205
    v_lshlrev_b32 v220, 16, v206
    v_and_b32 v221, 0xffff0000, v206
    v_lshlrev_b32 v222, 16, v207
    v_and_b32 v223, 0xffff0000, v207
    s_waitcnt vmcnt(0)
    v_cvt_f32_i32 v168, v168
    v_cvt_f32_i32 v169, v169
    v_cvt_f32_i32 v170, v170
    v_cvt_f32_i32 v171, v171
    v_cvt_f32_i32 v172, v172
    v_cvt_f32_i32 v173, v173
    v_cvt_f32_i32 v174, v174
    v_cvt_f32_i32 v175, v175
    v_cvt_pk_bf16_f32 v224, v168, v169
    v_cvt_pk_bf16_f32 v225, v170, v171
    v_cvt_pk_bf16_f32 v226, v172, v173
    v_cvt_pk_bf16_f32 v227, v174, v175
    v_lshlrev_b32 v168, 16, v224
    v_and_b32 v169, 0xffff0000, v224
    v_lshlrev_b32 v170, 16, v225
    v_and_b32 v171, 0xffff0000, v225
    v_lshlrev_b32 v172, 16, v226
    v_and_b32 v173, 0xffff0000, v226
    v_lshlrev_b32 v174, 16, v227
    v_and_b32 v175, 0xffff0000, v227
    v_pk_add_f32 v[168:169], v[168:169], v[216:217] op_sel:[0,0] op_sel_hi:[1,0] neg_lo:[0,1] neg_hi:[0,1]
    v_pk_add_f32 v[170:171], v[170:171], v[216:217] op_sel:[0,0] op_sel_hi:[1,0] neg_lo:[0,1] neg_hi:[0,1]
    v_pk_add_f32 v[172:173], v[172:173], v[216:217] op_sel:[0,1] op_sel_hi:[1,1] neg_lo:[0,1] neg_hi:[0,1]
    v_pk_add_f32 v[174:175], v[174:175], v[216:217] op_sel:[0,1] op_sel_hi:[1,1] neg_lo:[0,1] neg_hi:[0,1]
    v_cvt_pk_bf16_f32 v224, v168, v169
    v_cvt_pk_bf16_f32 v225, v170, v171
    v_cvt_pk_bf16_f32 v226, v172, v173
    v_cvt_pk_bf16_f32 v227, v174, v175
    v_lshlrev_b32 v168, 16, v224
    v_and_b32 v169, 0xffff0000, v224
    v_lshlrev_b32 v170, 16, v225
    v_and_b32 v171, 0xffff0000, v225
    v_lshlrev_b32 v172, 16, v226
    v_and_b32 v173, 0xffff0000, v226
    v_lshlrev_b32 v174, 16, v227
    v_and_b32 v175, 0xffff0000, v227
    v_pk_mul_f32 v[168:169], v[168:169], v[208:209] op_sel:[0,0] op_sel_hi:[1,0]
    v_pk_mul_f32 v[170:171], v[170:171], v[208:209] op_sel:[0,0] op_sel_hi:[1,0]
    v_pk_mul_f32 v[172:173], v[172:173], v[208:209] op_sel:[0,1] op_sel_hi:[1,1]
    v_pk_mul_f32 v[174:175], v[174:175], v[208:209] op_sel:[0,1] op_sel_hi:[1,1]
    v_cvt_f32_i32 v176, v176
    v_cvt_f32_i32 v177, v177
    v_cvt_f32_i32 v178, v178
    v_cvt_f32_i32 v179, v179
    v_cvt_f32_i32 v180, v180
    v_cvt_f32_i32 v181, v181
    v_cvt_f32_i32 v182, v182
    v_cvt_f32_i32 v183, v183
    v_cvt_pk_bf16_f32 v224, v176, v177
    v_cvt_pk_bf16_f32 v225, v178, v179
    v_cvt_pk_bf16_f32 v226, v180, v181
    v_cvt_pk_bf16_f32 v227, v182, v183
    v_lshlrev_b32 v176, 16, v224
    v_and_b32 v177, 0xffff0000, v224
    v_lshlrev_b32 v178, 16, v225
    v_and_b32 v179, 0xffff0000, v225
    v_lshlrev_b32 v180, 16, v226
    v_and_b32 v181, 0xffff0000, v226
    v_lshlrev_b32 v182, 16, v227
    v_and_b32 v183, 0xffff0000, v227
    v_pk_add_f32 v[176:177], v[176:177], v[218:219] op_sel:[0,0] op_sel_hi:[1,0] neg_lo:[0,1] neg_hi:[0,1]
    v_pk_add_f32 v[178:179], v[178:179], v[218:219] op_sel:[0,0] op_sel_hi:[1,0] neg_lo:[0,1] neg_hi:[0,1]
    v_pk_add_f32 v[180:181], v[180:181], v[218:219] op_sel:[0,1] op_sel_hi:[1,1] neg_lo:[0,1] neg_hi:[0,1]
    v_pk_add_f32 v[182:183], v[182:183], v[218:219] op_sel:[0,1] op_sel_hi:[1,1] neg_lo:[0,1] neg_hi:[0,1]
    v_cvt_pk_bf16_f32 v224, v176, v177
    v_cvt_pk_bf16_f32 v225, v178, v179
    v_cvt_pk_bf16_f32 v226, v180, v181
    v_cvt_pk_bf16_f32 v227, v182, v183
    v_lshlrev_b32 v176, 16, v224
    v_and_b32 v177, 0xffff0000, v224
    v_lshlrev_b32 v178, 16, v225
    v_and_b32 v179, 0xffff0000, v225
    v_lshlrev_b32 v180, 16, v226
    v_and_b32 v181, 0xffff0000, v226
    v_lshlrev_b32 v182, 16, v227
    v_and_b32 v183, 0xffff0000, v227
    v_pk_mul_f32 v[176:177], v[176:177], v[210:211] op_sel:[0,0] op_sel_hi:[1,0]
    v_pk_mul_f32 v[178:179], v[178:179], v[210:211] op_sel:[0,0] op_sel_hi:[1,0]
    v_pk_mul_f32 v[180:181], v[180:181], v[210:211] op_sel:[0,1] op_sel_hi:[1,1]
    v_pk_mul_f32 v[182:183], v[182:183], v[210:211] op_sel:[0,1] op_sel_hi:[1,1]
    v_cvt_f32_i32 v184, v184
    v_cvt_f32_i32 v185, v185
    v_cvt_f32_i32 v186, v186
    v_cvt_f32_i32 v187, v187
    v_cvt_f32_i32 v188, v188
    v_cvt_f32_i32 v189, v189
    v_cvt_f32_i32 v190, v190
    v_cvt_f32_i32 v191, v191
    v_cvt_pk_bf16_f32 v224, v184, v185
    v_cvt_pk_bf16_f32 v225, v186, v187
    v_cvt_pk_bf16_f32 v226, v188, v189
    v_cvt_pk_bf16_f32 v227, v190, v191
    v_lshlrev_b32 v184, 16, v224
    v_and_b32 v185, 0xffff0000, v224
    v_lshlrev_b32 v186, 16, v225
    v_and_b32 v187, 0xffff0000, v225
    v_lshlrev_b32 v188, 16, v226
    v_and_b32 v189, 0xffff0000, v226
    v_lshlrev_b32 v190, 16, v227
    v_and_b32 v191, 0xffff0000, v227
    v_pk_add_f32 v[184:185], v[184:185], v[220:221] op_sel:[0,0] op_sel_hi:[1,0] neg_lo:[0,1] neg_hi:[0,1]
    v_pk_add_f32 v[186:187], v[186:187], v[220:221] op_sel:[0,0] op_sel_hi:[1,0] neg_lo:[0,1] neg_hi:[0,1]
    v_pk_add_f32 v[188:189], v[188:189], v[220:221] op_sel:[0,1] op_sel_hi:[1,1] neg_lo:[0,1] neg_hi:[0,1]
    v_pk_add_f32 v[190:191], v[190:191], v[220:221] op_sel:[0,1] op_sel_hi:[1,1] neg_lo:[0,1] neg_hi:[0,1]
    v_cvt_pk_bf16_f32 v224, v184, v185
    v_cvt_pk_bf16_f32 v225, v186, v187
    v_cvt_pk_bf16_f32 v226, v188, v189
    v_cvt_pk_bf16_f32 v227, v190, v191
    v_lshlrev_b32 v184, 16, v224
    v_and_b32 v185, 0xffff0000, v224
    v_lshlrev_b32 v186, 16, v225
    v_and_b32 v187, 0xffff0000, v225
    v_lshlrev_b32 v188, 16, v226
    v_and_b32 v189, 0xffff0000, v226
    v_lshlrev_b32 v190, 16, v227
    v_and_b32 v191, 0xffff0000, v227
    v_pk_mul_f32 v[184:185], v[184:185], v[212:213] op_sel:[0,0] op_sel_hi:[1,0]
    v_pk_mul_f32 v[186:187], v[186:187], v[212:213] op_sel:[0,0] op_sel_hi:[1,0]
    v_pk_mul_f32 v[188:189], v[188:189], v[212:213] op_sel:[0,1] op_sel_hi:[1,1]
    v_pk_mul_f32 v[190:191], v[190:191], v[212:213] op_sel:[0,1] op_sel_hi:[1,1]
    v_cvt_f32_i32 v192, v192
    v_cvt_f32_i32 v193, v193
    v_cvt_f32_i32 v194, v194
    v_cvt_f32_i32 v195, v195
    v_cvt_f32_i32 v196, v196
    v_cvt_f32_i32 v197, v197
    v_cvt_f32_i32 v198, v198
    v_cvt_f32_i32 v199, v199
    v_cvt_pk_bf16_f32 v224, v192, v193
    v_cvt_pk_bf16_f32 v225, v194, v195
    v_cvt_pk_bf16_f32 v226, v196, v197
    v_cvt_pk_bf16_f32 v227, v198, v199
    v_lshlrev_b32 v192, 16, v224
    v_and_b32 v193, 0xffff0000, v224
    v_lshlrev_b32 v194, 16, v225
    v_and_b32 v195, 0xffff0000, v225
    v_lshlrev_b32 v196, 16, v226
    v_and_b32 v197, 0xffff0000, v226
    v_lshlrev_b32 v198, 16, v227
    v_and_b32 v199, 0xffff0000, v227
    v_pk_add_f32 v[192:193], v[192:193], v[222:223] op_sel:[0,0] op_sel_hi:[1,0] neg_lo:[0,1] neg_hi:[0,1]
    v_pk_add_f32 v[194:195], v[194:195], v[222:223] op_sel:[0,0] op_sel_hi:[1,0] neg_lo:[0,1] neg_hi:[0,1]
    v_pk_add_f32 v[196:197], v[196:197], v[222:223] op_sel:[0,1] op_sel_hi:[1,1] neg_lo:[0,1] neg_hi:[0,1]
    v_pk_add_f32 v[198:199], v[198:199], v[222:223] op_sel:[0,1] op_sel_hi:[1,1] neg_lo:[0,1] neg_hi:[0,1]
    v_cvt_pk_bf16_f32 v224, v192, v193
    v_cvt_pk_bf16_f32 v225, v194, v195
    v_cvt_pk_bf16_f32 v226, v196, v197
    v_cvt_pk_bf16_f32 v227, v198, v199
    v_lshlrev_b32 v192, 16, v224
    v_and_b32 v193, 0xffff0000, v224
    v_lshlrev_b32 v194, 16, v225
    v_and_b32 v195, 0xffff0000, v225
    v_lshlrev_b32 v196, 16, v226
    v_and_b32 v197, 0xffff0000, v226
    v_lshlrev_b32 v198, 16, v227
    v_and_b32 v199, 0xffff0000, v227
    v_pk_mul_f32 v[192:193], v[192:193], v[214:215] op_sel:[0,0] op_sel_hi:[1,0]
    v_pk_mul_f32 v[194:195], v[194:195], v[214:215] op_sel:[0,0] op_sel_hi:[1,0]
    v_pk_mul_f32 v[196:197], v[196:197], v[214:215] op_sel:[0,1] op_sel_hi:[1,1]
    v_pk_mul_f32 v[198:199], v[198:199], v[214:215] op_sel:[0,1] op_sel_hi:[1,1]
    v_cvt_pk_bf16_f32 v232, v168, v172
    v_cvt_pk_bf16_f32 v233, v176, v180
    v_cvt_pk_bf16_f32 v234, v184, v188
    v_cvt_pk_bf16_f32 v235, v192, v196
    buffer_store_dwordx4 v[232:235], v1, s[8:11], s82 offen offset:0 sc1
    v_cvt_pk_bf16_f32 v236, v169, v173
    v_cvt_pk_bf16_f32 v237, v177, v181
    v_cvt_pk_bf16_f32 v238, v185, v189
    v_cvt_pk_bf16_f32 v239, v193, v197
    buffer_store_dwordx4 v[236:239], v1, s[8:11], s82 offen offset:1024 sc1
    v_cvt_pk_bf16_f32 v240, v170, v174
    v_cvt_pk_bf16_f32 v241, v178, v182
    v_cvt_pk_bf16_f32 v242, v186, v190
    v_cvt_pk_bf16_f32 v243, v194, v198
    buffer_store_dwordx4 v[240:243], v1, s[8:11], s82 offen offset:2048 sc1
    v_cvt_pk_bf16_f32 v244, v171, v175
    v_cvt_pk_bf16_f32 v245, v179, v183
    v_cvt_pk_bf16_f32 v246, v187, v191
    v_cvt_pk_bf16_f32 v247, v195, v199
    buffer_store_dwordx4 v[244:247], v1, s[8:11], s82 offen offset:3072 sc1
    s_waitcnt vmcnt(0)
    s_setpc_b64 s[84:85]
.section .rodata,"a"
.p2align 6
.amdhsa_kernel standalone__kv_cache_quant_int4_int2_kv_with_per_channel_or_per_token_scales__prompt_kernel
  .amdhsa_next_free_vgpr 512
  .amdhsa_next_free_sgpr 102
  .amdhsa_accum_offset 256
  .amdhsa_group_segment_fixed_size 0
  .amdhsa_kernarg_size 80
  .amdhsa_user_sgpr_count 2
  .amdhsa_user_sgpr_kernarg_segment_ptr 1
  .amdhsa_system_sgpr_workgroup_id_x 1
  .amdhsa_float_denorm_mode_32 3
  .amdhsa_float_denorm_mode_16_64 3
.end_amdhsa_kernel
```
